```python
import torch

def _softmax(x, axis=-1):
    return torch.softmax(x, dim=axis)
def _gelu(x):
    return torch.nn.functional.gelu(x, approximate="tanh")
def _silu(x):
    return torch.nn.functional.silu(x)
def _sigmoid(x):
    return torch.sigmoid(x)
def _layernorm(x, axis=-1, eps=1e-5):
    m = x.mean(dim=axis, keepdim=True)
    v = x.var(dim=axis, keepdim=True, unbiased=False)
    return (x - m) / torch.sqrt(v + eps)
def _scatter_add(tgt, idx, src, axis=0):
    return tgt.clone().index_add_(axis, idx, src)
def _segment_sum(src, seg, n):
    out = torch.zeros((n,) + src.shape[1:], dtype=src.dtype)
    return out.index_add_(0, seg, src)
def _pad(x, pw):
    flat = tuple(v for pair in reversed(pw) for v in pair)
    return torch.nn.functional.pad(x, flat)

kernel_name = 'standalone__weight_only_int_squeezellm__prompt'

def setup_inputs():

    _w = (lambda a: (lambda t: t.to(torch.bfloat16) if t.is_floating_point() else t)(torch.as_tensor(a)))
    B, S, D, F = 1, 2048, 1024, 3584
    bits = 3 if (2 <= 3 <= 4) else 4
    L = 2 ** bits
    qw = torch.randint(0, L, (D, F)).to(torch.int64)
    lut = (lambda *s: torch.randn(*s, dtype=torch.bfloat16) * 0.05)(L, F)
    return {
        "x": _w((lambda *s: torch.randn(*s, dtype=torch.bfloat16) * 0.05)(B, S, D)),
        "qw": _w(qw),
        "lut": _w(lut),
    }

def reference(x, qw, lut):
    w = (lambda x, i, axis: torch.take_along_dim(x, i, dim=axis))(lut, qw, axis=0)
    w = (lambda x, dt: x.to(dt))(w, x.dtype)
    return torch.einsum('bsd,df->bsf', x, w)
```

```asm
; @launch grid=(256,1,1) block=(512,1,1) lds=159744
.amdgcn_target "amdgcn-amd-amdhsa--gfx950"
.text
.globl standalone__weight_only_int_squeezellm__prompt_kernel
.p2align 8
.type standalone__weight_only_int_squeezellm__prompt_kernel,@function
standalone__weight_only_int_squeezellm__prompt_kernel:
    s_cmp_ge_u32 s2, 256
    s_cbranch_scc1 L_end
    s_load_dwordx8 s[4:11], s[0:1], 0
    s_and_b32 s28, s2, 7
    s_lshr_b32 s29, s2, 3
    s_and_b32 s29, s29, 3
    s_lshl_b32 s28, s28, 2
    s_add_u32 s29, s29, s28
    s_lshr_b32 s28, s2, 5
    s_lshl_b32 s30, s28, 8
    s_mul_i32 s31, s29, 112
    v_lshrrev_b32 v1, 6, v0
    v_and_b32 v0, 63, v0
    s_mov_b32 s32, 0x05010400
    v_readfirstlane_b32 s36, v1
    s_mov_b32 s33, 0x07030602
    s_mov_b32 s34, 0x05040100
    s_mov_b32 s35, 0x07060302
    s_and_b32 s37, s36, 3
    v_lshrrev_b32 v3, 3, v0
    v_and_b32 v4, 7, v0
    v_lshrrev_b32 v5, 4, v0
    v_xor_b32 v4, v4, v5
    v_lshlrev_b32 v4, 4, v4
    v_lshl_add_u32 v3, v3, 11, v4
    s_lshl_b32 s42, s37, 6
    s_add_u32 s42, s42, s30
    s_lshl_b32 s42, s42, 11
    v_add_u32 v3, s42, v3
    v_xor_b32 v4, 64, v3
    v_add_u32 v24, 0, v3
    v_add_u32 v25, 15360, v4
    v_add_u32 v26, 30720, v3
    v_add_u32 v27, 46080, v4
    v_add_u32 v28, 65536, v3
    v_add_u32 v29, 80896, v4
    v_add_u32 v30, 96256, v3
    v_add_u32 v31, 111616, v4
    s_lshl_b32 s49, s37, 13
    s_cmp_ge_u32 s36, 4
    s_cbranch_scc1 L_producer
    s_getpc_b64 s[64:65]
L_pc:
    s_sub_u32 s64, s64, L_pc-standalone__weight_only_int_squeezellm__prompt_kernel
    s_subb_u32 s65, s65, 0
    s_lshl_b32 s42, s36, 10
    v_lshlrev_b32 v2, 4, v0
    v_add_u32 v2, s42, v2
    v_min_u32 v3, L_codeend-standalone__weight_only_int_squeezellm__prompt_kernel-16, v2
    global_load_dwordx4 v[244:247], v3, s[64:65]
    v_add_u32 v2, 0x1000, v2
    v_min_u32 v3, L_codeend-standalone__weight_only_int_squeezellm__prompt_kernel-16, v2
    global_load_dwordx4 v[244:247], v3, s[64:65]
    v_add_u32 v2, 0x1000, v2
    v_min_u32 v3, L_codeend-standalone__weight_only_int_squeezellm__prompt_kernel-16, v2
    global_load_dwordx4 v[244:247], v3, s[64:65]
    v_add_u32 v2, 0x1000, v2
    v_min_u32 v3, L_codeend-standalone__weight_only_int_squeezellm__prompt_kernel-16, v2
    global_load_dwordx4 v[244:247], v3, s[64:65]
    v_add_u32 v2, 0x1000, v2
    s_waitcnt lgkmcnt(0)
    s_mov_b32 s12, s4
    s_and_b32 s13, s5, 0xffff
    s_mov_b32 s14, 4194304
    s_mov_b32 s15, 0x00020000
    s_mov_b32 s16, s6
    s_and_b32 s17, s7, 0xffff
    s_mov_b32 s18, 14680064
    s_mov_b32 s19, 0x00020000
    s_lshr_b32 s42, s2, 3
    s_lshl_b32 s42, s42, 1
    s_lshr_b32 s43, s36, 1
    s_add_u32 s42, s42, s43
    s_mul_i32 s42, s42, 14336
    s_and_b32 s43, s2, 7
    s_mul_i32 s43, s43, 1792
    s_add_u32 s42, s42, s43
    s_and_b32 s43, s36, 1
    s_mul_i32 s43, s43, 896
    s_add_u32 s47, s42, s43
    v_lshlrev_b32 v1, 4, v0
    v_bfrev_b32 v2, 1
    v_cmp_gt_u32 vcc, 56, v0
    v_lshrrev_b32 v3, 3, v0
    v_lshlrev_b32 v3, 11, v3
    v_cndmask_b32 v240, v2, v1, vcc
    v_and_b32 v2, 7, v0
    v_lshl_add_u32 v241, v2, 4, v3
    s_lshl_b32 s55, s2, 14
    s_lshl_b32 s42, s36, 7
    s_add_u32 s55, s55, s42
    buffer_load_dwordx4 v[244:247], v240, s[16:19], s47 offen
    s_add_u32 s47, s47, 917504
    buffer_load_dwordx4 v[244:247], v241, s[12:15], s55 offen offset:0
L_cx0:
    buffer_load_dwordx4 v[244:247], v240, s[16:19], s47 offen
    s_add_u32 s47, s47, 917504
    buffer_load_dwordx4 v[244:247], v240, s[16:19], s47 offen
    s_add_u32 s47, s47, 917504
    buffer_load_dwordx4 v[244:247], v240, s[16:19], s47 offen
    s_add_u32 s47, s47, 917504
    s_mov_b32 s41, 0
    s_add_u32 m0, s49, 0
    s_nop 0
    buffer_load_dwordx4 v24, s[12:15], s41 offen offset:0 lds
    buffer_load_dwordx4 v25, s[12:15], s41 offen offset:1024 lds
    buffer_load_dwordx4 v26, s[12:15], s41 offen offset:2048 lds
    buffer_load_dwordx4 v27, s[12:15], s41 offen offset:3072 lds
    s_add_u32 m0, s49, 4096
    s_nop 0
    buffer_load_dwordx4 v28, s[12:15], s41 offen offset:0 lds
    buffer_load_dwordx4 v29, s[12:15], s41 offen offset:1024 lds
    buffer_load_dwordx4 v30, s[12:15], s41 offen offset:2048 lds
    buffer_load_dwordx4 v31, s[12:15], s41 offen offset:3072 lds
    s_mov_b32 s41, 128
    s_add_u32 m0, s49, 32768
    s_nop 0
    buffer_load_dwordx4 v24, s[12:15], s41 offen offset:0 lds
    buffer_load_dwordx4 v25, s[12:15], s41 offen offset:1024 lds
    buffer_load_dwordx4 v26, s[12:15], s41 offen offset:2048 lds
    buffer_load_dwordx4 v27, s[12:15], s41 offen offset:3072 lds
    s_add_u32 m0, s49, 36864
    s_nop 0
    buffer_load_dwordx4 v28, s[12:15], s41 offen offset:0 lds
    buffer_load_dwordx4 v29, s[12:15], s41 offen offset:1024 lds
    buffer_load_dwordx4 v30, s[12:15], s41 offen offset:2048 lds
    buffer_load_dwordx4 v31, s[12:15], s41 offen offset:3072 lds
    s_mov_b32 s41, 256
    s_add_u32 m0, s49, 65536
    s_nop 0
    buffer_load_dwordx4 v24, s[12:15], s41 offen offset:0 lds
    buffer_load_dwordx4 v25, s[12:15], s41 offen offset:1024 lds
    buffer_load_dwordx4 v26, s[12:15], s41 offen offset:2048 lds
    buffer_load_dwordx4 v27, s[12:15], s41 offen offset:3072 lds
    s_mov_b32 s16, s6
    s_and_b32 s17, s7, 0xffff
    s_mov_b32 s18, 14680064
    s_mov_b32 s19, 0x00020000
    s_mov_b32 s24, s10
    s_and_b32 s25, s11, 0xffff
    s_mov_b32 s26, 14680064
    s_mov_b32 s27, 0x00020000
    s_lshr_b32 s42, s2, 3
    s_lshr_b32 s45, s42, 1
    s_and_b32 s42, s42, 1
    s_lshl_b32 s47, s45, 6
    s_lshl_b32 s43, s42, 5
    s_add_u32 s47, s47, s43
    s_lshl_b32 s43, s36, 3
    s_add_u32 s47, s47, s43
    s_mul_i32 s47, s47, 14336
    s_and_b32 s43, s2, 7
    s_mul_i32 s55, s43, 1792
    s_add_u32 s47, s47, s55
    s_lshl_b32 s55, s43, 1
    s_add_u32 s55, s55, s42
    s_lshl_b32 s55, s55, 2
    s_add_u32 s55, s55, s36
    s_lshl_b32 s55, s55, 16
    s_lshl_b32 s43, s45, 7
    s_add_u32 s55, s55, s43
    v_lshlrev_b32 v1, 4, v0
    v_bfrev_b32 v2, 1
    v_cmp_gt_u32 vcc, 56, v0
    v_lshrrev_b32 v3, 3, v0
    v_lshlrev_b32 v3, 11, v3
    v_cndmask_b32 v240, v2, v1, vcc
    v_and_b32 v2, 7, v0
    v_lshl_add_u32 v241, v2, 4, v3
    s_cmp_lt_u32 s45, 4
    s_cselect_b32 s42, 99, 0
    s_sub_i32 s45, s45, 6
    s_max_i32 s45, s45, 0
    s_add_u32 s45, s45, s42
    s_mov_b32 s46, 0
    s_mov_b32 s71, 0
    s_mov_b32 s72, s45
    s_cmp_lg_u32 s46, s45
    s_cbranch_scc1 L_bskip1
    s_getpc_b64 s[50:51]
    s_add_u32 s50, s50, 12
    s_addc_u32 s51, s51, 0
    s_branch L_burst
L_bskip1:
    s_add_u32 s46, s46, 1
    v_and_b32 v110, 15, v0
    v_lshrrev_b32 v111, 4, v0
    s_lshl_b32 s42, s36, 13
    v_lshrrev_b32 v1, 1, v110
    v_xor_b32 v1, v111, v1
    v_lshlrev_b32 v1, 4, v1
    v_lshl_add_u32 v104, v110, 7, v1
    v_add_u32 v2, s42, v104
    v_add_u32 v3, 0x10000, v2
    v_xor_b32 v4, 64, v2
    v_xor_b32 v5, 64, v3
    v_add_u32 v10, 143360, v104
    v_xor_b32 v11, 64, v10
    v_lshrrev_b32 v1, 2, v110
    v_and_b32 v105, 3, v110
    v_lshl_add_u32 v105, v1, 3, v105
    v_lshlrev_b32 v105, 7, v105
    v_lshlrev_b32 v1, 1, v1
    v_xor_b32 v1, v111, v1
    v_bfe_u32 v106, v110, 1, 1
    v_xor_b32 v1, v1, v106
    v_lshl_add_u32 v105, v1, 4, v105
    v_add_u32 v6, 131072, v105
    v_xor_b32 v1, 16, v6
    v_add_u32 v7, 512, v1
    v_xor_b32 v8, 64, v6
    v_xor_b32 v9, 64, v7
    s_lshl_b32 s42, s36, 14
    v_mul_u32_u24 v1, 240, v110
    v_add_u32 v1, s42, v1
    v_lshl_add_u32 v13, v111, 4, v1
    v_lshl_add_u32 v14, v111, 3, v1
    v_mul_u32_u24 v1, 4682, v0
    v_lshrrev_b32 v1, 16, v1
    v_mul_u32_u24 v105, 14, v1
    v_sub_u32 v105, v0, v105
    v_mul_u32_u24 v106, 240, v1
    v_lshl_add_u32 v106, v105, 4, v106
    v_add_u32 v15, s42, v106
    s_lshl_b32 s42, s36, 6
    s_add_u32 s42, s42, s30
    v_add_u32 v1, s42, v1
    v_mul_u32_u24 v1, 7168, v1
    s_lshl_b32 s43, s31, 1
    v_add_u32 v1, s43, v1
    v_lshl_add_u32 v12, v105, 4, v1
    v_cmp_gt_u32 vcc, 56, v0
    v_bfrev_b32 v1, 1
    s_nop 0
    v_cndmask_b32 v12, v1, v12, vcc
    v_cndmask_b32 v15, v13, v15, vcc
    v_mov_b32 v128, 0
    v_mov_b32 v129, 0
    v_mov_b32 v130, 0
    v_mov_b32 v131, 0
    v_mov_b32 v132, 0
    v_mov_b32 v133, 0
    v_mov_b32 v134, 0
    v_mov_b32 v135, 0
    v_mov_b32 v136, 0
    v_mov_b32 v137, 0
    v_mov_b32 v138, 0
    v_mov_b32 v139, 0
    v_mov_b32 v140, 0
    v_mov_b32 v141, 0
    v_mov_b32 v142, 0
    v_mov_b32 v143, 0
    v_mov_b32 v144, 0
    v_mov_b32 v145, 0
    v_mov_b32 v146, 0
    v_mov_b32 v147, 0
    v_mov_b32 v148, 0
    v_mov_b32 v149, 0
    v_mov_b32 v150, 0
    v_mov_b32 v151, 0
    v_mov_b32 v152, 0
    v_mov_b32 v153, 0
    v_mov_b32 v154, 0
    v_mov_b32 v155, 0
    v_mov_b32 v156, 0
    v_mov_b32 v157, 0
    v_mov_b32 v158, 0
    v_mov_b32 v159, 0
    v_mov_b32 v160, 0
    v_mov_b32 v161, 0
    v_mov_b32 v162, 0
    v_mov_b32 v163, 0
    v_mov_b32 v164, 0
    v_mov_b32 v165, 0
    v_mov_b32 v166, 0
    v_mov_b32 v167, 0
    v_mov_b32 v168, 0
    v_mov_b32 v169, 0
    v_mov_b32 v170, 0
    v_mov_b32 v171, 0
    v_mov_b32 v172, 0
    v_mov_b32 v173, 0
    v_mov_b32 v174, 0
    v_mov_b32 v175, 0
    v_mov_b32 v176, 0
    v_mov_b32 v177, 0
    v_mov_b32 v178, 0
    v_mov_b32 v179, 0
    v_mov_b32 v180, 0
    v_mov_b32 v181, 0
    v_mov_b32 v182, 0
    v_mov_b32 v183, 0
    v_mov_b32 v184, 0
    v_mov_b32 v185, 0
    v_mov_b32 v186, 0
    v_mov_b32 v187, 0
    v_mov_b32 v188, 0
    v_mov_b32 v189, 0
    v_mov_b32 v190, 0
    v_mov_b32 v191, 0
    v_mov_b32 v192, 0
    v_mov_b32 v193, 0
    v_mov_b32 v194, 0
    v_mov_b32 v195, 0
    v_mov_b32 v196, 0
    v_mov_b32 v197, 0
    v_mov_b32 v198, 0
    v_mov_b32 v199, 0
    v_mov_b32 v200, 0
    v_mov_b32 v201, 0
    v_mov_b32 v202, 0
    v_mov_b32 v203, 0
    v_mov_b32 v204, 0
    v_mov_b32 v205, 0
    v_mov_b32 v206, 0
    v_mov_b32 v207, 0
    v_mov_b32 v208, 0
    v_mov_b32 v209, 0
    v_mov_b32 v210, 0
    v_mov_b32 v211, 0
    v_mov_b32 v212, 0
    v_mov_b32 v213, 0
    v_mov_b32 v214, 0
    v_mov_b32 v215, 0
    v_mov_b32 v216, 0
    v_mov_b32 v217, 0
    v_mov_b32 v218, 0
    v_mov_b32 v219, 0
    v_mov_b32 v220, 0
    v_mov_b32 v221, 0
    v_mov_b32 v222, 0
    v_mov_b32 v223, 0
    v_mov_b32 v224, 0
    v_mov_b32 v225, 0
    v_mov_b32 v226, 0
    v_mov_b32 v227, 0
    v_mov_b32 v228, 0
    v_mov_b32 v229, 0
    v_mov_b32 v230, 0
    v_mov_b32 v231, 0
    v_mov_b32 v232, 0
    v_mov_b32 v233, 0
    v_mov_b32 v234, 0
    v_mov_b32 v235, 0
    v_mov_b32 v236, 0
    v_mov_b32 v237, 0
    v_mov_b32 v238, 0
    v_mov_b32 v239, 0
    s_cmp_eq_u32 s72, 0
    s_cbranch_scc1 L_cw1
    s_waitcnt vmcnt(12)
    s_branch L_cw2
L_cw1:
    s_waitcnt vmcnt(32)
L_cw2:
    s_barrier
    ds_read_b128 v[48:51], v6 offset:0
    ds_read_b128 v[32:35], v2 offset:0
    ds_read_b128 v[36:39], v2 offset:2048
    ds_read_b128 v[40:43], v2 offset:4096
    ds_read_b128 v[44:47], v2 offset:6144
    ds_read_b128 v[52:55], v7 offset:0
    ds_read_b128 v[56:59], v6 offset:4096
    ds_read_b128 v[60:63], v7 offset:4096
    ds_read_b128 v[64:67], v6 offset:8192
    ds_read_b128 v[68:71], v7 offset:8192
    ds_read_b128 v[72:75], v10 offset:0
    s_mov_b32 s48, 0
    s_waitcnt lgkmcnt(0)
L_cloop:
    v_mfma_f32_16x16x32_bf16 v[128:131], v[48:51], v[32:35], v[128:131]
    ds_read_b128 v[92:95], v8 offset:0
    v_mfma_f32_16x16x32_bf16 v[132:135], v[48:51], v[36:39], v[132:135]
    ds_read_b128 v[76:79], v4 offset:0
    v_mfma_f32_16x16x32_bf16 v[136:139], v[48:51], v[40:43], v[136:139]
    ds_read_b128 v[80:83], v4 offset:2048
    v_mfma_f32_16x16x32_bf16 v[140:143], v[48:51], v[44:47], v[140:143]
    ds_read_b128 v[84:87], v4 offset:4096
    v_mfma_f32_16x16x32_bf16 v[144:147], v[52:55], v[32:35], v[144:147]
    ds_read_b128 v[88:91], v4 offset:6144
    v_mfma_f32_16x16x32_bf16 v[148:151], v[52:55], v[36:39], v[148:151]
    ds_read_b128 v[96:99], v9 offset:0
    v_mfma_f32_16x16x32_bf16 v[152:155], v[52:55], v[40:43], v[152:155]
    ds_read_b128 v[100:103], v8 offset:4096
    v_mfma_f32_16x16x32_bf16 v[156:159], v[52:55], v[44:47], v[156:159]
    ds_read_b128 v[104:107], v9 offset:4096
    v_mfma_f32_16x16x32_bf16 v[160:163], v[56:59], v[32:35], v[160:163]
    ds_read_b128 v[108:111], v8 offset:8192
    v_mfma_f32_16x16x32_bf16 v[164:167], v[56:59], v[36:39], v[164:167]
    ds_read_b128 v[112:115], v9 offset:8192
    v_mfma_f32_16x16x32_bf16 v[168:171], v[56:59], v[40:43], v[168:171]
    ds_read_b128 v[116:119], v11 offset:0
    v_mfma_f32_16x16x32_bf16 v[172:175], v[56:59], v[44:47], v[172:175]
    s_add_u32 m0, s49, 69632
    v_mfma_f32_16x16x32_bf16 v[176:179], v[60:63], v[32:35], v[176:179]
    buffer_load_dwordx4 v28, s[12:15], s41 offen offset:0 lds
    v_mfma_f32_16x16x32_bf16 v[180:183], v[60:63], v[36:39], v[180:183]
    v_mfma_f32_16x16x32_bf16 v[184:187], v[60:63], v[40:43], v[184:187]
    v_mfma_f32_16x16x32_bf16 v[188:191], v[60:63], v[44:47], v[188:191]
    v_mfma_f32_16x16x32_bf16 v[192:195], v[64:67], v[32:35], v[192:195]
    buffer_load_dwordx4 v29, s[12:15], s41 offen offset:1024 lds
    v_mfma_f32_16x16x32_bf16 v[196:199], v[64:67], v[36:39], v[196:199]
    v_mfma_f32_16x16x32_bf16 v[200:203], v[64:67], v[40:43], v[200:203]
    v_mfma_f32_16x16x32_bf16 v[204:207], v[64:67], v[44:47], v[204:207]
    v_mfma_f32_16x16x32_bf16 v[208:211], v[68:71], v[32:35], v[208:211]
    buffer_load_dwordx4 v30, s[12:15], s41 offen offset:2048 lds
    v_mfma_f32_16x16x32_bf16 v[212:215], v[68:71], v[36:39], v[212:215]
    v_mfma_f32_16x16x32_bf16 v[216:219], v[68:71], v[40:43], v[216:219]
    v_mfma_f32_16x16x32_bf16 v[220:223], v[68:71], v[44:47], v[220:223]
    v_mfma_f32_16x16x32_bf16 v[224:227], v[72:75], v[32:35], v[224:227]
    buffer_load_dwordx4 v31, s[12:15], s41 offen offset:3072 lds
    s_add_u32 s41, s41, 128
    v_mfma_f32_16x16x32_bf16 v[228:231], v[72:75], v[36:39], v[228:231]
    v_mfma_f32_16x16x32_bf16 v[232:235], v[72:75], v[40:43], v[232:235]
    v_mfma_f32_16x16x32_bf16 v[236:239], v[72:75], v[44:47], v[236:239]
    s_waitcnt vmcnt(8) lgkmcnt(0)
    s_barrier
    v_mfma_f32_16x16x32_bf16 v[128:131], v[92:95], v[76:79], v[128:131]
    ds_read_b128 v[48:51], v6 offset:14336
    v_mfma_f32_16x16x32_bf16 v[132:135], v[92:95], v[80:83], v[132:135]
    ds_read_b128 v[32:35], v2 offset:32768
    v_mfma_f32_16x16x32_bf16 v[136:139], v[92:95], v[84:87], v[136:139]
    ds_read_b128 v[36:39], v2 offset:34816
    v_mfma_f32_16x16x32_bf16 v[140:143], v[92:95], v[88:91], v[140:143]
    ds_read_b128 v[40:43], v2 offset:36864
    v_mfma_f32_16x16x32_bf16 v[144:147], v[96:99], v[76:79], v[144:147]
    ds_read_b128 v[44:47], v2 offset:38912
    v_mfma_f32_16x16x32_bf16 v[148:151], v[96:99], v[80:83], v[148:151]
    ds_read_b128 v[52:55], v7 offset:14336
    v_mfma_f32_16x16x32_bf16 v[152:155], v[96:99], v[84:87], v[152:155]
    ds_read_b128 v[56:59], v6 offset:18432
    v_mfma_f32_16x16x32_bf16 v[156:159], v[96:99], v[88:91], v[156:159]
    ds_read_b128 v[60:63], v7 offset:18432
    v_mfma_f32_16x16x32_bf16 v[160:163], v[100:103], v[76:79], v[160:163]
    ds_read_b128 v[64:67], v6 offset:22528
    v_mfma_f32_16x16x32_bf16 v[164:167], v[100:103], v[80:83], v[164:167]
    ds_read_b128 v[68:71], v7 offset:22528
    v_mfma_f32_16x16x32_bf16 v[168:171], v[100:103], v[84:87], v[168:171]
    ds_read_b128 v[72:75], v10 offset:14336
    s_cmp_lg_u32 s46, s45
    s_cbranch_scc1 L_bskip2
    s_getpc_b64 s[50:51]
    s_add_u32 s50, s50, 12
    s_addc_u32 s51, s51, 0
    s_branch L_burst
L_bskip2:
    s_add_u32 s46, s46, 1
    v_mfma_f32_16x16x32_bf16 v[172:175], v[100:103], v[88:91], v[172:175]
    s_add_u32 m0, s49, 98304
    v_mfma_f32_16x16x32_bf16 v[176:179], v[104:107], v[76:79], v[176:179]
    buffer_load_dwordx4 v24, s[12:15], s41 offen offset:0 lds
    v_mfma_f32_16x16x32_bf16 v[180:183], v[104:107], v[80:83], v[180:183]
    v_mfma_f32_16x16x32_bf16 v[184:187], v[104:107], v[84:87], v[184:187]
    v_mfma_f32_16x16x32_bf16 v[188:191], v[104:107], v[88:91], v[188:191]
    v_mfma_f32_16x16x32_bf16 v[192:195], v[108:111], v[76:79], v[192:195]
    buffer_load_dwordx4 v25, s[12:15], s41 offen offset:1024 lds
    v_mfma_f32_16x16x32_bf16 v[196:199], v[108:111], v[80:83], v[196:199]
    v_mfma_f32_16x16x32_bf16 v[200:203], v[108:111], v[84:87], v[200:203]
    v_mfma_f32_16x16x32_bf16 v[204:207], v[108:111], v[88:91], v[204:207]
    v_mfma_f32_16x16x32_bf16 v[208:211], v[112:115], v[76:79], v[208:211]
    buffer_load_dwordx4 v26, s[12:15], s41 offen offset:2048 lds
    v_mfma_f32_16x16x32_bf16 v[212:215], v[112:115], v[80:83], v[212:215]
    v_mfma_f32_16x16x32_bf16 v[216:219], v[112:115], v[84:87], v[216:219]
    v_mfma_f32_16x16x32_bf16 v[220:223], v[112:115], v[88:91], v[220:223]
    v_mfma_f32_16x16x32_bf16 v[224:227], v[116:119], v[76:79], v[224:227]
    buffer_load_dwordx4 v27, s[12:15], s41 offen offset:3072 lds
    v_mfma_f32_16x16x32_bf16 v[228:231], v[116:119], v[80:83], v[228:231]
    v_mfma_f32_16x16x32_bf16 v[232:235], v[116:119], v[84:87], v[232:235]
    v_mfma_f32_16x16x32_bf16 v[236:239], v[116:119], v[88:91], v[236:239]
    s_waitcnt lgkmcnt(0)
    v_mfma_f32_16x16x32_bf16 v[128:131], v[48:51], v[32:35], v[128:131]
    ds_read_b128 v[92:95], v8 offset:14336
    v_mfma_f32_16x16x32_bf16 v[132:135], v[48:51], v[36:39], v[132:135]
    ds_read_b128 v[76:79], v4 offset:32768
    v_mfma_f32_16x16x32_bf16 v[136:139], v[48:51], v[40:43], v[136:139]
    ds_read_b128 v[80:83], v4 offset:34816
    v_mfma_f32_16x16x32_bf16 v[140:143], v[48:51], v[44:47], v[140:143]
    ds_read_b128 v[84:87], v4 offset:36864
    v_mfma_f32_16x16x32_bf16 v[144:147], v[52:55], v[32:35], v[144:147]
    ds_read_b128 v[88:91], v4 offset:38912
    v_mfma_f32_16x16x32_bf16 v[148:151], v[52:55], v[36:39], v[148:151]
    ds_read_b128 v[96:99], v9 offset:14336
    v_mfma_f32_16x16x32_bf16 v[152:155], v[52:55], v[40:43], v[152:155]
    ds_read_b128 v[100:103], v8 offset:18432
    v_mfma_f32_16x16x32_bf16 v[156:159], v[52:55], v[44:47], v[156:159]
    ds_read_b128 v[104:107], v9 offset:18432
    v_mfma_f32_16x16x32_bf16 v[160:163], v[56:59], v[32:35], v[160:163]
    ds_read_b128 v[108:111], v8 offset:22528
    v_mfma_f32_16x16x32_bf16 v[164:167], v[56:59], v[36:39], v[164:167]
    ds_read_b128 v[112:115], v9 offset:22528
    v_mfma_f32_16x16x32_bf16 v[168:171], v[56:59], v[40:43], v[168:171]
    ds_read_b128 v[116:119], v11 offset:14336
    v_mfma_f32_16x16x32_bf16 v[172:175], v[56:59], v[44:47], v[172:175]
    s_add_u32 m0, s49, 102400
    v_mfma_f32_16x16x32_bf16 v[176:179], v[60:63], v[32:35], v[176:179]
    buffer_load_dwordx4 v28, s[12:15], s41 offen offset:0 lds
    v_mfma_f32_16x16x32_bf16 v[180:183], v[60:63], v[36:39], v[180:183]
    v_mfma_f32_16x16x32_bf16 v[184:187], v[60:63], v[40:43], v[184:187]
    v_mfma_f32_16x16x32_bf16 v[188:191], v[60:63], v[44:47], v[188:191]
    v_mfma_f32_16x16x32_bf16 v[192:195], v[64:67], v[32:35], v[192:195]
    buffer_load_dwordx4 v29, s[12:15], s41 offen offset:1024 lds
    v_mfma_f32_16x16x32_bf16 v[196:199], v[64:67], v[36:39], v[196:199]
    v_mfma_f32_16x16x32_bf16 v[200:203], v[64:67], v[40:43], v[200:203]
    v_mfma_f32_16x16x32_bf16 v[204:207], v[64:67], v[44:47], v[204:207]
    v_mfma_f32_16x16x32_bf16 v[208:211], v[68:71], v[32:35], v[208:211]
    buffer_load_dwordx4 v30, s[12:15], s41 offen offset:2048 lds
    v_mfma_f32_16x16x32_bf16 v[212:215], v[68:71], v[36:39], v[212:215]
    v_mfma_f32_16x16x32_bf16 v[216:219], v[68:71], v[40:43], v[216:219]
    v_mfma_f32_16x16x32_bf16 v[220:223], v[68:71], v[44:47], v[220:223]
    v_mfma_f32_16x16x32_bf16 v[224:227], v[72:75], v[32:35], v[224:227]
    buffer_load_dwordx4 v31, s[12:15], s41 offen offset:3072 lds
    s_add_u32 s41, s41, 128
    v_mfma_f32_16x16x32_bf16 v[228:231], v[72:75], v[36:39], v[228:231]
    v_mfma_f32_16x16x32_bf16 v[232:235], v[72:75], v[40:43], v[232:235]
    v_mfma_f32_16x16x32_bf16 v[236:239], v[72:75], v[44:47], v[236:239]
    s_waitcnt vmcnt(8) lgkmcnt(0)
    s_barrier
    v_mfma_f32_16x16x32_bf16 v[128:131], v[92:95], v[76:79], v[128:131]
    ds_read_b128 v[48:51], v6 offset:0
    v_mfma_f32_16x16x32_bf16 v[132:135], v[92:95], v[80:83], v[132:135]
    ds_read_b128 v[32:35], v3 offset:0
    v_mfma_f32_16x16x32_bf16 v[136:139], v[92:95], v[84:87], v[136:139]
    ds_read_b128 v[36:39], v3 offset:2048
    v_mfma_f32_16x16x32_bf16 v[140:143], v[92:95], v[88:91], v[140:143]
    ds_read_b128 v[40:43], v3 offset:4096
    v_mfma_f32_16x16x32_bf16 v[144:147], v[96:99], v[76:79], v[144:147]
    ds_read_b128 v[44:47], v3 offset:6144
    v_mfma_f32_16x16x32_bf16 v[148:151], v[96:99], v[80:83], v[148:151]
    ds_read_b128 v[52:55], v7 offset:0
    v_mfma_f32_16x16x32_bf16 v[152:155], v[96:99], v[84:87], v[152:155]
    ds_read_b128 v[56:59], v6 offset:4096
    v_mfma_f32_16x16x32_bf16 v[156:159], v[96:99], v[88:91], v[156:159]
    ds_read_b128 v[60:63], v7 offset:4096
    v_mfma_f32_16x16x32_bf16 v[160:163], v[100:103], v[76:79], v[160:163]
    ds_read_b128 v[64:67], v6 offset:8192
    v_mfma_f32_16x16x32_bf16 v[164:167], v[100:103], v[80:83], v[164:167]
    ds_read_b128 v[68:71], v7 offset:8192
    v_mfma_f32_16x16x32_bf16 v[168:171], v[100:103], v[84:87], v[168:171]
    ds_read_b128 v[72:75], v10 offset:0
    s_cmp_lg_u32 s46, s45
    s_cbranch_scc1 L_bskip3
    s_getpc_b64 s[50:51]
    s_add_u32 s50, s50, 12
    s_addc_u32 s51, s51, 0
    s_branch L_burst
L_bskip3:
    s_add_u32 s46, s46, 1
    v_mfma_f32_16x16x32_bf16 v[172:175], v[100:103], v[88:91], v[172:175]
    s_add_u32 m0, s49, 0
    v_mfma_f32_16x16x32_bf16 v[176:179], v[104:107], v[76:79], v[176:179]
    buffer_load_dwordx4 v24, s[12:15], s41 offen offset:0 lds
    v_mfma_f32_16x16x32_bf16 v[180:183], v[104:107], v[80:83], v[180:183]
    v_mfma_f32_16x16x32_bf16 v[184:187], v[104:107], v[84:87], v[184:187]
    v_mfma_f32_16x16x32_bf16 v[188:191], v[104:107], v[88:91], v[188:191]
    v_mfma_f32_16x16x32_bf16 v[192:195], v[108:111], v[76:79], v[192:195]
    buffer_load_dwordx4 v25, s[12:15], s41 offen offset:1024 lds
    v_mfma_f32_16x16x32_bf16 v[196:199], v[108:111], v[80:83], v[196:199]
    v_mfma_f32_16x16x32_bf16 v[200:203], v[108:111], v[84:87], v[200:203]
    v_mfma_f32_16x16x32_bf16 v[204:207], v[108:111], v[88:91], v[204:207]
    v_mfma_f32_16x16x32_bf16 v[208:211], v[112:115], v[76:79], v[208:211]
    buffer_load_dwordx4 v26, s[12:15], s41 offen offset:2048 lds
    v_mfma_f32_16x16x32_bf16 v[212:215], v[112:115], v[80:83], v[212:215]
    v_mfma_f32_16x16x32_bf16 v[216:219], v[112:115], v[84:87], v[216:219]
    v_mfma_f32_16x16x32_bf16 v[220:223], v[112:115], v[88:91], v[220:223]
    v_mfma_f32_16x16x32_bf16 v[224:227], v[116:119], v[76:79], v[224:227]
    buffer_load_dwordx4 v27, s[12:15], s41 offen offset:3072 lds
    v_mfma_f32_16x16x32_bf16 v[228:231], v[116:119], v[80:83], v[228:231]
    v_mfma_f32_16x16x32_bf16 v[232:235], v[116:119], v[84:87], v[232:235]
    v_mfma_f32_16x16x32_bf16 v[236:239], v[116:119], v[88:91], v[236:239]
    s_waitcnt lgkmcnt(0)
    v_mfma_f32_16x16x32_bf16 v[128:131], v[48:51], v[32:35], v[128:131]
    ds_read_b128 v[92:95], v8 offset:0
    v_mfma_f32_16x16x32_bf16 v[132:135], v[48:51], v[36:39], v[132:135]
    ds_read_b128 v[76:79], v5 offset:0
    v_mfma_f32_16x16x32_bf16 v[136:139], v[48:51], v[40:43], v[136:139]
    ds_read_b128 v[80:83], v5 offset:2048
    v_mfma_f32_16x16x32_bf16 v[140:143], v[48:51], v[44:47], v[140:143]
    ds_read_b128 v[84:87], v5 offset:4096
    v_mfma_f32_16x16x32_bf16 v[144:147], v[52:55], v[32:35], v[144:147]
    ds_read_b128 v[88:91], v5 offset:6144
    v_mfma_f32_16x16x32_bf16 v[148:151], v[52:55], v[36:39], v[148:151]
    ds_read_b128 v[96:99], v9 offset:0
    v_mfma_f32_16x16x32_bf16 v[152:155], v[52:55], v[40:43], v[152:155]
    ds_read_b128 v[100:103], v8 offset:4096
    v_mfma_f32_16x16x32_bf16 v[156:159], v[52:55], v[44:47], v[156:159]
    ds_read_b128 v[104:107], v9 offset:4096
    v_mfma_f32_16x16x32_bf16 v[160:163], v[56:59], v[32:35], v[160:163]
    ds_read_b128 v[108:111], v8 offset:8192
    v_mfma_f32_16x16x32_bf16 v[164:167], v[56:59], v[36:39], v[164:167]
    ds_read_b128 v[112:115], v9 offset:8192
    v_mfma_f32_16x16x32_bf16 v[168:171], v[56:59], v[40:43], v[168:171]
    ds_read_b128 v[116:119], v11 offset:0
    v_mfma_f32_16x16x32_bf16 v[172:175], v[56:59], v[44:47], v[172:175]
    s_add_u32 m0, s49, 4096
    v_mfma_f32_16x16x32_bf16 v[176:179], v[60:63], v[32:35], v[176:179]
    buffer_load_dwordx4 v28, s[12:15], s41 offen offset:0 lds
    v_mfma_f32_16x16x32_bf16 v[180:183], v[60:63], v[36:39], v[180:183]
    v_mfma_f32_16x16x32_bf16 v[184:187], v[60:63], v[40:43], v[184:187]
    v_mfma_f32_16x16x32_bf16 v[188:191], v[60:63], v[44:47], v[188:191]
    v_mfma_f32_16x16x32_bf16 v[192:195], v[64:67], v[32:35], v[192:195]
    buffer_load_dwordx4 v29, s[12:15], s41 offen offset:1024 lds
    v_mfma_f32_16x16x32_bf16 v[196:199], v[64:67], v[36:39], v[196:199]
    v_mfma_f32_16x16x32_bf16 v[200:203], v[64:67], v[40:43], v[200:203]
    v_mfma_f32_16x16x32_bf16 v[204:207], v[64:67], v[44:47], v[204:207]
    v_mfma_f32_16x16x32_bf16 v[208:211], v[68:71], v[32:35], v[208:211]
    buffer_load_dwordx4 v30, s[12:15], s41 offen offset:2048 lds
    v_mfma_f32_16x16x32_bf16 v[212:215], v[68:71], v[36:39], v[212:215]
    v_mfma_f32_16x16x32_bf16 v[216:219], v[68:71], v[40:43], v[216:219]
    v_mfma_f32_16x16x32_bf16 v[220:223], v[68:71], v[44:47], v[220:223]
    v_mfma_f32_16x16x32_bf16 v[224:227], v[72:75], v[32:35], v[224:227]
    buffer_load_dwordx4 v31, s[12:15], s41 offen offset:3072 lds
    s_add_u32 s41, s41, 128
    v_mfma_f32_16x16x32_bf16 v[228:231], v[72:75], v[36:39], v[228:231]
    v_mfma_f32_16x16x32_bf16 v[232:235], v[72:75], v[40:43], v[232:235]
    v_mfma_f32_16x16x32_bf16 v[236:239], v[72:75], v[44:47], v[236:239]
    s_waitcnt vmcnt(8) lgkmcnt(0)
    s_barrier
    v_mfma_f32_16x16x32_bf16 v[128:131], v[92:95], v[76:79], v[128:131]
    ds_read_b128 v[48:51], v6 offset:14336
    v_mfma_f32_16x16x32_bf16 v[132:135], v[92:95], v[80:83], v[132:135]
    ds_read_b128 v[32:35], v3 offset:32768
    v_mfma_f32_16x16x32_bf16 v[136:139], v[92:95], v[84:87], v[136:139]
    ds_read_b128 v[36:39], v3 offset:34816
    v_mfma_f32_16x16x32_bf16 v[140:143], v[92:95], v[88:91], v[140:143]
    ds_read_b128 v[40:43], v3 offset:36864
    v_mfma_f32_16x16x32_bf16 v[144:147], v[96:99], v[76:79], v[144:147]
    ds_read_b128 v[44:47], v3 offset:38912
    v_mfma_f32_16x16x32_bf16 v[148:151], v[96:99], v[80:83], v[148:151]
    ds_read_b128 v[52:55], v7 offset:14336
    v_mfma_f32_16x16x32_bf16 v[152:155], v[96:99], v[84:87], v[152:155]
    ds_read_b128 v[56:59], v6 offset:18432
    v_mfma_f32_16x16x32_bf16 v[156:159], v[96:99], v[88:91], v[156:159]
    ds_read_b128 v[60:63], v7 offset:18432
    v_mfma_f32_16x16x32_bf16 v[160:163], v[100:103], v[76:79], v[160:163]
    ds_read_b128 v[64:67], v6 offset:22528
    v_mfma_f32_16x16x32_bf16 v[164:167], v[100:103], v[80:83], v[164:167]
    ds_read_b128 v[68:71], v7 offset:22528
    v_mfma_f32_16x16x32_bf16 v[168:171], v[100:103], v[84:87], v[168:171]
    ds_read_b128 v[72:75], v10 offset:14336
    s_cmp_lg_u32 s46, s45
    s_cbranch_scc1 L_bskip4
    s_getpc_b64 s[50:51]
    s_add_u32 s50, s50, 12
    s_addc_u32 s51, s51, 0
    s_branch L_burst
L_bskip4:
    s_add_u32 s46, s46, 1
    v_mfma_f32_16x16x32_bf16 v[172:175], v[100:103], v[88:91], v[172:175]
    s_add_u32 m0, s49, 32768
    v_mfma_f32_16x16x32_bf16 v[176:179], v[104:107], v[76:79], v[176:179]
    buffer_load_dwordx4 v24, s[12:15], s41 offen offset:0 lds
    v_mfma_f32_16x16x32_bf16 v[180:183], v[104:107], v[80:83], v[180:183]
    v_mfma_f32_16x16x32_bf16 v[184:187], v[104:107], v[84:87], v[184:187]
    v_mfma_f32_16x16x32_bf16 v[188:191], v[104:107], v[88:91], v[188:191]
    v_mfma_f32_16x16x32_bf16 v[192:195], v[108:111], v[76:79], v[192:195]
    buffer_load_dwordx4 v25, s[12:15], s41 offen offset:1024 lds
    v_mfma_f32_16x16x32_bf16 v[196:199], v[108:111], v[80:83], v[196:199]
    v_mfma_f32_16x16x32_bf16 v[200:203], v[108:111], v[84:87], v[200:203]
    v_mfma_f32_16x16x32_bf16 v[204:207], v[108:111], v[88:91], v[204:207]
    v_mfma_f32_16x16x32_bf16 v[208:211], v[112:115], v[76:79], v[208:211]
    buffer_load_dwordx4 v26, s[12:15], s41 offen offset:2048 lds
    v_mfma_f32_16x16x32_bf16 v[212:215], v[112:115], v[80:83], v[212:215]
    v_mfma_f32_16x16x32_bf16 v[216:219], v[112:115], v[84:87], v[216:219]
    v_mfma_f32_16x16x32_bf16 v[220:223], v[112:115], v[88:91], v[220:223]
    v_mfma_f32_16x16x32_bf16 v[224:227], v[116:119], v[76:79], v[224:227]
    buffer_load_dwordx4 v27, s[12:15], s41 offen offset:3072 lds
    v_mfma_f32_16x16x32_bf16 v[228:231], v[116:119], v[80:83], v[228:231]
    v_mfma_f32_16x16x32_bf16 v[232:235], v[116:119], v[84:87], v[232:235]
    v_mfma_f32_16x16x32_bf16 v[236:239], v[116:119], v[88:91], v[236:239]
    s_waitcnt lgkmcnt(0)
    v_mfma_f32_16x16x32_bf16 v[128:131], v[48:51], v[32:35], v[128:131]
    ds_read_b128 v[92:95], v8 offset:14336
    v_mfma_f32_16x16x32_bf16 v[132:135], v[48:51], v[36:39], v[132:135]
    ds_read_b128 v[76:79], v5 offset:32768
    v_mfma_f32_16x16x32_bf16 v[136:139], v[48:51], v[40:43], v[136:139]
    ds_read_b128 v[80:83], v5 offset:34816
    v_mfma_f32_16x16x32_bf16 v[140:143], v[48:51], v[44:47], v[140:143]
    ds_read_b128 v[84:87], v5 offset:36864
    v_mfma_f32_16x16x32_bf16 v[144:147], v[52:55], v[32:35], v[144:147]
    ds_read_b128 v[88:91], v5 offset:38912
    v_mfma_f32_16x16x32_bf16 v[148:151], v[52:55], v[36:39], v[148:151]
    ds_read_b128 v[96:99], v9 offset:14336
    v_mfma_f32_16x16x32_bf16 v[152:155], v[52:55], v[40:43], v[152:155]
    ds_read_b128 v[100:103], v8 offset:18432
    v_mfma_f32_16x16x32_bf16 v[156:159], v[52:55], v[44:47], v[156:159]
    ds_read_b128 v[104:107], v9 offset:18432
    v_mfma_f32_16x16x32_bf16 v[160:163], v[56:59], v[32:35], v[160:163]
    ds_read_b128 v[108:111], v8 offset:22528
    v_mfma_f32_16x16x32_bf16 v[164:167], v[56:59], v[36:39], v[164:167]
    ds_read_b128 v[112:115], v9 offset:22528
    v_mfma_f32_16x16x32_bf16 v[168:171], v[56:59], v[40:43], v[168:171]
    ds_read_b128 v[116:119], v11 offset:14336
    v_mfma_f32_16x16x32_bf16 v[172:175], v[56:59], v[44:47], v[172:175]
    s_add_u32 m0, s49, 36864
    v_mfma_f32_16x16x32_bf16 v[176:179], v[60:63], v[32:35], v[176:179]
    buffer_load_dwordx4 v28, s[12:15], s41 offen offset:0 lds
    v_mfma_f32_16x16x32_bf16 v[180:183], v[60:63], v[36:39], v[180:183]
    v_mfma_f32_16x16x32_bf16 v[184:187], v[60:63], v[40:43], v[184:187]
    v_mfma_f32_16x16x32_bf16 v[188:191], v[60:63], v[44:47], v[188:191]
    v_mfma_f32_16x16x32_bf16 v[192:195], v[64:67], v[32:35], v[192:195]
    buffer_load_dwordx4 v29, s[12:15], s41 offen offset:1024 lds
    v_mfma_f32_16x16x32_bf16 v[196:199], v[64:67], v[36:39], v[196:199]
    v_mfma_f32_16x16x32_bf16 v[200:203], v[64:67], v[40:43], v[200:203]
    v_mfma_f32_16x16x32_bf16 v[204:207], v[64:67], v[44:47], v[204:207]
    v_mfma_f32_16x16x32_bf16 v[208:211], v[68:71], v[32:35], v[208:211]
    buffer_load_dwordx4 v30, s[12:15], s41 offen offset:2048 lds
    v_mfma_f32_16x16x32_bf16 v[212:215], v[68:71], v[36:39], v[212:215]
    v_mfma_f32_16x16x32_bf16 v[216:219], v[68:71], v[40:43], v[216:219]
    v_mfma_f32_16x16x32_bf16 v[220:223], v[68:71], v[44:47], v[220:223]
    v_mfma_f32_16x16x32_bf16 v[224:227], v[72:75], v[32:35], v[224:227]
    buffer_load_dwordx4 v31, s[12:15], s41 offen offset:3072 lds
    s_add_u32 s41, s41, 128
    v_mfma_f32_16x16x32_bf16 v[228:231], v[72:75], v[36:39], v[228:231]
    v_mfma_f32_16x16x32_bf16 v[232:235], v[72:75], v[40:43], v[232:235]
    v_mfma_f32_16x16x32_bf16 v[236:239], v[72:75], v[44:47], v[236:239]
    s_waitcnt vmcnt(8) lgkmcnt(0)
    s_barrier
    v_mfma_f32_16x16x32_bf16 v[128:131], v[92:95], v[76:79], v[128:131]
    ds_read_b128 v[48:51], v6 offset:0
    v_mfma_f32_16x16x32_bf16 v[132:135], v[92:95], v[80:83], v[132:135]
    ds_read_b128 v[32:35], v2 offset:0
    v_mfma_f32_16x16x32_bf16 v[136:139], v[92:95], v[84:87], v[136:139]
    ds_read_b128 v[36:39], v2 offset:2048
    v_mfma_f32_16x16x32_bf16 v[140:143], v[92:95], v[88:91], v[140:143]
    ds_read_b128 v[40:43], v2 offset:4096
    v_mfma_f32_16x16x32_bf16 v[144:147], v[96:99], v[76:79], v[144:147]
    ds_read_b128 v[44:47], v2 offset:6144
    v_mfma_f32_16x16x32_bf16 v[148:151], v[96:99], v[80:83], v[148:151]
    ds_read_b128 v[52:55], v7 offset:0
    v_mfma_f32_16x16x32_bf16 v[152:155], v[96:99], v[84:87], v[152:155]
    ds_read_b128 v[56:59], v6 offset:4096
    v_mfma_f32_16x16x32_bf16 v[156:159], v[96:99], v[88:91], v[156:159]
    ds_read_b128 v[60:63], v7 offset:4096
    v_mfma_f32_16x16x32_bf16 v[160:163], v[100:103], v[76:79], v[160:163]
    ds_read_b128 v[64:67], v6 offset:8192
    v_mfma_f32_16x16x32_bf16 v[164:167], v[100:103], v[80:83], v[164:167]
    ds_read_b128 v[68:71], v7 offset:8192
    v_mfma_f32_16x16x32_bf16 v[168:171], v[100:103], v[84:87], v[168:171]
    ds_read_b128 v[72:75], v10 offset:0
    s_cmp_lg_u32 s46, s45
    s_cbranch_scc1 L_bskip5
    s_getpc_b64 s[50:51]
    s_add_u32 s50, s50, 12
    s_addc_u32 s51, s51, 0
    s_branch L_burst
L_bskip5:
    s_add_u32 s46, s46, 1
    v_mfma_f32_16x16x32_bf16 v[172:175], v[100:103], v[88:91], v[172:175]
    s_add_u32 m0, s49, 65536
    v_mfma_f32_16x16x32_bf16 v[176:179], v[104:107], v[76:79], v[176:179]
    buffer_load_dwordx4 v24, s[12:15], s41 offen offset:0 lds
    v_mfma_f32_16x16x32_bf16 v[180:183], v[104:107], v[80:83], v[180:183]
    v_mfma_f32_16x16x32_bf16 v[184:187], v[104:107], v[84:87], v[184:187]
    v_mfma_f32_16x16x32_bf16 v[188:191], v[104:107], v[88:91], v[188:191]
    v_mfma_f32_16x16x32_bf16 v[192:195], v[108:111], v[76:79], v[192:195]
    buffer_load_dwordx4 v25, s[12:15], s41 offen offset:1024 lds
    v_mfma_f32_16x16x32_bf16 v[196:199], v[108:111], v[80:83], v[196:199]
    v_mfma_f32_16x16x32_bf16 v[200:203], v[108:111], v[84:87], v[200:203]
    v_mfma_f32_16x16x32_bf16 v[204:207], v[108:111], v[88:91], v[204:207]
    v_mfma_f32_16x16x32_bf16 v[208:211], v[112:115], v[76:79], v[208:211]
    buffer_load_dwordx4 v26, s[12:15], s41 offen offset:2048 lds
    v_mfma_f32_16x16x32_bf16 v[212:215], v[112:115], v[80:83], v[212:215]
    v_mfma_f32_16x16x32_bf16 v[216:219], v[112:115], v[84:87], v[216:219]
    v_mfma_f32_16x16x32_bf16 v[220:223], v[112:115], v[88:91], v[220:223]
    v_mfma_f32_16x16x32_bf16 v[224:227], v[116:119], v[76:79], v[224:227]
    buffer_load_dwordx4 v27, s[12:15], s41 offen offset:3072 lds
    v_mfma_f32_16x16x32_bf16 v[228:231], v[116:119], v[80:83], v[228:231]
    v_mfma_f32_16x16x32_bf16 v[232:235], v[116:119], v[84:87], v[232:235]
    v_mfma_f32_16x16x32_bf16 v[236:239], v[116:119], v[88:91], v[236:239]
    s_waitcnt lgkmcnt(0)
    s_add_u32 s48, s48, 1
    s_cmp_lt_u32 s48, 3
    s_cbranch_scc1 L_cloop
    v_mfma_f32_16x16x32_bf16 v[128:131], v[48:51], v[32:35], v[128:131]
    ds_read_b128 v[92:95], v8 offset:0
    v_mfma_f32_16x16x32_bf16 v[132:135], v[48:51], v[36:39], v[132:135]
    ds_read_b128 v[76:79], v4 offset:0
    v_mfma_f32_16x16x32_bf16 v[136:139], v[48:51], v[40:43], v[136:139]
    ds_read_b128 v[80:83], v4 offset:2048
    v_mfma_f32_16x16x32_bf16 v[140:143], v[48:51], v[44:47], v[140:143]
    ds_read_b128 v[84:87], v4 offset:4096
    v_mfma_f32_16x16x32_bf16 v[144:147], v[52:55], v[32:35], v[144:147]
    ds_read_b128 v[88:91], v4 offset:6144
    v_mfma_f32_16x16x32_bf16 v[148:151], v[52:55], v[36:39], v[148:151]
    ds_read_b128 v[96:99], v9 offset:0
    v_mfma_f32_16x16x32_bf16 v[152:155], v[52:55], v[40:43], v[152:155]
    ds_read_b128 v[100:103], v8 offset:4096
    v_mfma_f32_16x16x32_bf16 v[156:159], v[52:55], v[44:47], v[156:159]
    ds_read_b128 v[104:107], v9 offset:4096
    v_mfma_f32_16x16x32_bf16 v[160:163], v[56:59], v[32:35], v[160:163]
    ds_read_b128 v[108:111], v8 offset:8192
    v_mfma_f32_16x16x32_bf16 v[164:167], v[56:59], v[36:39], v[164:167]
    ds_read_b128 v[112:115], v9 offset:8192
    v_mfma_f32_16x16x32_bf16 v[168:171], v[56:59], v[40:43], v[168:171]
    ds_read_b128 v[116:119], v11 offset:0
    v_mfma_f32_16x16x32_bf16 v[172:175], v[56:59], v[44:47], v[172:175]
    s_add_u32 m0, s49, 69632
    v_mfma_f32_16x16x32_bf16 v[176:179], v[60:63], v[32:35], v[176:179]
    buffer_load_dwordx4 v28, s[12:15], s41 offen offset:0 lds
    v_mfma_f32_16x16x32_bf16 v[180:183], v[60:63], v[36:39], v[180:183]
    v_mfma_f32_16x16x32_bf16 v[184:187], v[60:63], v[40:43], v[184:187]
    v_mfma_f32_16x16x32_bf16 v[188:191], v[60:63], v[44:47], v[188:191]
    v_mfma_f32_16x16x32_bf16 v[192:195], v[64:67], v[32:35], v[192:195]
    buffer_load_dwordx4 v29, s[12:15], s41 offen offset:1024 lds
    v_mfma_f32_16x16x32_bf16 v[196:199], v[64:67], v[36:39], v[196:199]
    v_mfma_f32_16x16x32_bf16 v[200:203], v[64:67], v[40:43], v[200:203]
    v_mfma_f32_16x16x32_bf16 v[204:207], v[64:67], v[44:47], v[204:207]
    v_mfma_f32_16x16x32_bf16 v[208:211], v[68:71], v[32:35], v[208:211]
    buffer_load_dwordx4 v30, s[12:15], s41 offen offset:2048 lds
    v_mfma_f32_16x16x32_bf16 v[212:215], v[68:71], v[36:39], v[212:215]
    v_mfma_f32_16x16x32_bf16 v[216:219], v[68:71], v[40:43], v[216:219]
    v_mfma_f32_16x16x32_bf16 v[220:223], v[68:71], v[44:47], v[220:223]
    v_mfma_f32_16x16x32_bf16 v[224:227], v[72:75], v[32:35], v[224:227]
    buffer_load_dwordx4 v31, s[12:15], s41 offen offset:3072 lds
    s_add_u32 s41, s41, 128
    v_mfma_f32_16x16x32_bf16 v[228:231], v[72:75], v[36:39], v[228:231]
    v_mfma_f32_16x16x32_bf16 v[232:235], v[72:75], v[40:43], v[232:235]
    v_mfma_f32_16x16x32_bf16 v[236:239], v[72:75], v[44:47], v[236:239]
    s_waitcnt vmcnt(8) lgkmcnt(0)
    s_barrier
    v_mfma_f32_16x16x32_bf16 v[128:131], v[92:95], v[76:79], v[128:131]
    ds_read_b128 v[48:51], v6 offset:14336
    v_mfma_f32_16x16x32_bf16 v[132:135], v[92:95], v[80:83], v[132:135]
    ds_read_b128 v[32:35], v2 offset:32768
    v_mfma_f32_16x16x32_bf16 v[136:139], v[92:95], v[84:87], v[136:139]
    ds_read_b128 v[36:39], v2 offset:34816
    v_mfma_f32_16x16x32_bf16 v[140:143], v[92:95], v[88:91], v[140:143]
    ds_read_b128 v[40:43], v2 offset:36864
    v_mfma_f32_16x16x32_bf16 v[144:147], v[96:99], v[76:79], v[144:147]
    ds_read_b128 v[44:47], v2 offset:38912
    v_mfma_f32_16x16x32_bf16 v[148:151], v[96:99], v[80:83], v[148:151]
    ds_read_b128 v[52:55], v7 offset:14336
    v_mfma_f32_16x16x32_bf16 v[152:155], v[96:99], v[84:87], v[152:155]
    ds_read_b128 v[56:59], v6 offset:18432
    v_mfma_f32_16x16x32_bf16 v[156:159], v[96:99], v[88:91], v[156:159]
    ds_read_b128 v[60:63], v7 offset:18432
    v_mfma_f32_16x16x32_bf16 v[160:163], v[100:103], v[76:79], v[160:163]
    ds_read_b128 v[64:67], v6 offset:22528
    v_mfma_f32_16x16x32_bf16 v[164:167], v[100:103], v[80:83], v[164:167]
    ds_read_b128 v[68:71], v7 offset:22528
    v_mfma_f32_16x16x32_bf16 v[168:171], v[100:103], v[84:87], v[168:171]
    ds_read_b128 v[72:75], v10 offset:14336
    v_mfma_f32_16x16x32_bf16 v[172:175], v[100:103], v[88:91], v[172:175]
    s_add_u32 m0, s49, 98304
    v_mfma_f32_16x16x32_bf16 v[176:179], v[104:107], v[76:79], v[176:179]
    buffer_load_dwordx4 v24, s[12:15], s41 offen offset:0 lds
    v_mfma_f32_16x16x32_bf16 v[180:183], v[104:107], v[80:83], v[180:183]
    v_mfma_f32_16x16x32_bf16 v[184:187], v[104:107], v[84:87], v[184:187]
    v_mfma_f32_16x16x32_bf16 v[188:191], v[104:107], v[88:91], v[188:191]
    v_mfma_f32_16x16x32_bf16 v[192:195], v[108:111], v[76:79], v[192:195]
    buffer_load_dwordx4 v25, s[12:15], s41 offen offset:1024 lds
    v_mfma_f32_16x16x32_bf16 v[196:199], v[108:111], v[80:83], v[196:199]
    v_mfma_f32_16x16x32_bf16 v[200:203], v[108:111], v[84:87], v[200:203]
    v_mfma_f32_16x16x32_bf16 v[204:207], v[108:111], v[88:91], v[204:207]
    v_mfma_f32_16x16x32_bf16 v[208:211], v[112:115], v[76:79], v[208:211]
    buffer_load_dwordx4 v26, s[12:15], s41 offen offset:2048 lds
    v_mfma_f32_16x16x32_bf16 v[212:215], v[112:115], v[80:83], v[212:215]
    v_mfma_f32_16x16x32_bf16 v[216:219], v[112:115], v[84:87], v[216:219]
    v_mfma_f32_16x16x32_bf16 v[220:223], v[112:115], v[88:91], v[220:223]
    v_mfma_f32_16x16x32_bf16 v[224:227], v[116:119], v[76:79], v[224:227]
    buffer_load_dwordx4 v27, s[12:15], s41 offen offset:3072 lds
    v_mfma_f32_16x16x32_bf16 v[228:231], v[116:119], v[80:83], v[228:231]
    v_mfma_f32_16x16x32_bf16 v[232:235], v[116:119], v[84:87], v[232:235]
    v_mfma_f32_16x16x32_bf16 v[236:239], v[116:119], v[88:91], v[236:239]
    s_waitcnt lgkmcnt(0)
    v_mfma_f32_16x16x32_bf16 v[128:131], v[48:51], v[32:35], v[128:131]
    ds_read_b128 v[92:95], v8 offset:14336
    v_mfma_f32_16x16x32_bf16 v[132:135], v[48:51], v[36:39], v[132:135]
    ds_read_b128 v[76:79], v4 offset:32768
    v_mfma_f32_16x16x32_bf16 v[136:139], v[48:51], v[40:43], v[136:139]
    ds_read_b128 v[80:83], v4 offset:34816
    v_mfma_f32_16x16x32_bf16 v[140:143], v[48:51], v[44:47], v[140:143]
    ds_read_b128 v[84:87], v4 offset:36864
    v_mfma_f32_16x16x32_bf16 v[144:147], v[52:55], v[32:35], v[144:147]
    ds_read_b128 v[88:91], v4 offset:38912
    v_mfma_f32_16x16x32_bf16 v[148:151], v[52:55], v[36:39], v[148:151]
    ds_read_b128 v[96:99], v9 offset:14336
    v_mfma_f32_16x16x32_bf16 v[152:155], v[52:55], v[40:43], v[152:155]
    ds_read_b128 v[100:103], v8 offset:18432
    v_mfma_f32_16x16x32_bf16 v[156:159], v[52:55], v[44:47], v[156:159]
    ds_read_b128 v[104:107], v9 offset:18432
    v_mfma_f32_16x16x32_bf16 v[160:163], v[56:59], v[32:35], v[160:163]
    ds_read_b128 v[108:111], v8 offset:22528
    v_mfma_f32_16x16x32_bf16 v[164:167], v[56:59], v[36:39], v[164:167]
    ds_read_b128 v[112:115], v9 offset:22528
    v_mfma_f32_16x16x32_bf16 v[168:171], v[56:59], v[40:43], v[168:171]
    ds_read_b128 v[116:119], v11 offset:14336
    v_mfma_f32_16x16x32_bf16 v[172:175], v[56:59], v[44:47], v[172:175]
    s_add_u32 m0, s49, 102400
    v_mfma_f32_16x16x32_bf16 v[176:179], v[60:63], v[32:35], v[176:179]
    buffer_load_dwordx4 v28, s[12:15], s41 offen offset:0 lds
    v_mfma_f32_16x16x32_bf16 v[180:183], v[60:63], v[36:39], v[180:183]
    v_mfma_f32_16x16x32_bf16 v[184:187], v[60:63], v[40:43], v[184:187]
    v_mfma_f32_16x16x32_bf16 v[188:191], v[60:63], v[44:47], v[188:191]
    v_mfma_f32_16x16x32_bf16 v[192:195], v[64:67], v[32:35], v[192:195]
    buffer_load_dwordx4 v29, s[12:15], s41 offen offset:1024 lds
    v_mfma_f32_16x16x32_bf16 v[196:199], v[64:67], v[36:39], v[196:199]
    v_mfma_f32_16x16x32_bf16 v[200:203], v[64:67], v[40:43], v[200:203]
    v_mfma_f32_16x16x32_bf16 v[204:207], v[64:67], v[44:47], v[204:207]
    v_mfma_f32_16x16x32_bf16 v[208:211], v[68:71], v[32:35], v[208:211]
    buffer_load_dwordx4 v30, s[12:15], s41 offen offset:2048 lds
    v_mfma_f32_16x16x32_bf16 v[212:215], v[68:71], v[36:39], v[212:215]
    v_mfma_f32_16x16x32_bf16 v[216:219], v[68:71], v[40:43], v[216:219]
    v_mfma_f32_16x16x32_bf16 v[220:223], v[68:71], v[44:47], v[220:223]
    v_mfma_f32_16x16x32_bf16 v[224:227], v[72:75], v[32:35], v[224:227]
    buffer_load_dwordx4 v31, s[12:15], s41 offen offset:3072 lds
    s_add_u32 s41, s41, 128
    v_mfma_f32_16x16x32_bf16 v[228:231], v[72:75], v[36:39], v[228:231]
    v_mfma_f32_16x16x32_bf16 v[232:235], v[72:75], v[40:43], v[232:235]
    v_mfma_f32_16x16x32_bf16 v[236:239], v[72:75], v[44:47], v[236:239]
    s_waitcnt vmcnt(8) lgkmcnt(0)
    s_barrier
    v_mfma_f32_16x16x32_bf16 v[128:131], v[92:95], v[76:79], v[128:131]
    ds_read_b128 v[48:51], v6 offset:0
    v_mfma_f32_16x16x32_bf16 v[132:135], v[92:95], v[80:83], v[132:135]
    ds_read_b128 v[32:35], v3 offset:0
    v_mfma_f32_16x16x32_bf16 v[136:139], v[92:95], v[84:87], v[136:139]
    ds_read_b128 v[36:39], v3 offset:2048
    v_mfma_f32_16x16x32_bf16 v[140:143], v[92:95], v[88:91], v[140:143]
    ds_read_b128 v[40:43], v3 offset:4096
    v_mfma_f32_16x16x32_bf16 v[144:147], v[96:99], v[76:79], v[144:147]
    ds_read_b128 v[44:47], v3 offset:6144
    v_mfma_f32_16x16x32_bf16 v[148:151], v[96:99], v[80:83], v[148:151]
    ds_read_b128 v[52:55], v7 offset:0
    v_mfma_f32_16x16x32_bf16 v[152:155], v[96:99], v[84:87], v[152:155]
    ds_read_b128 v[56:59], v6 offset:4096
    v_mfma_f32_16x16x32_bf16 v[156:159], v[96:99], v[88:91], v[156:159]
    ds_read_b128 v[60:63], v7 offset:4096
    v_mfma_f32_16x16x32_bf16 v[160:163], v[100:103], v[76:79], v[160:163]
    ds_read_b128 v[64:67], v6 offset:8192
    v_mfma_f32_16x16x32_bf16 v[164:167], v[100:103], v[80:83], v[164:167]
    ds_read_b128 v[68:71], v7 offset:8192
    v_mfma_f32_16x16x32_bf16 v[168:171], v[100:103], v[84:87], v[168:171]
    ds_read_b128 v[72:75], v10 offset:0
    v_mfma_f32_16x16x32_bf16 v[172:175], v[100:103], v[88:91], v[172:175]
    v_mfma_f32_16x16x32_bf16 v[176:179], v[104:107], v[76:79], v[176:179]
    v_mfma_f32_16x16x32_bf16 v[180:183], v[104:107], v[80:83], v[180:183]
    v_mfma_f32_16x16x32_bf16 v[184:187], v[104:107], v[84:87], v[184:187]
    v_mfma_f32_16x16x32_bf16 v[188:191], v[104:107], v[88:91], v[188:191]
    v_mfma_f32_16x16x32_bf16 v[192:195], v[108:111], v[76:79], v[192:195]
    v_mfma_f32_16x16x32_bf16 v[196:199], v[108:111], v[80:83], v[196:199]
    v_mfma_f32_16x16x32_bf16 v[200:203], v[108:111], v[84:87], v[200:203]
    v_mfma_f32_16x16x32_bf16 v[204:207], v[108:111], v[88:91], v[204:207]
    v_mfma_f32_16x16x32_bf16 v[208:211], v[112:115], v[76:79], v[208:211]
    v_mfma_f32_16x16x32_bf16 v[212:215], v[112:115], v[80:83], v[212:215]
    v_mfma_f32_16x16x32_bf16 v[216:219], v[112:115], v[84:87], v[216:219]
    v_mfma_f32_16x16x32_bf16 v[220:223], v[112:115], v[88:91], v[220:223]
    v_mfma_f32_16x16x32_bf16 v[224:227], v[116:119], v[76:79], v[224:227]
    v_mfma_f32_16x16x32_bf16 v[228:231], v[116:119], v[80:83], v[228:231]
    v_mfma_f32_16x16x32_bf16 v[232:235], v[116:119], v[84:87], v[232:235]
    v_mfma_f32_16x16x32_bf16 v[236:239], v[116:119], v[88:91], v[236:239]
    s_waitcnt lgkmcnt(0)
    v_mfma_f32_16x16x32_bf16 v[128:131], v[48:51], v[32:35], v[128:131]
    ds_read_b128 v[92:95], v8 offset:0
    v_mfma_f32_16x16x32_bf16 v[132:135], v[48:51], v[36:39], v[132:135]
    ds_read_b128 v[76:79], v5 offset:0
    v_mfma_f32_16x16x32_bf16 v[136:139], v[48:51], v[40:43], v[136:139]
    ds_read_b128 v[80:83], v5 offset:2048
    v_mfma_f32_16x16x32_bf16 v[140:143], v[48:51], v[44:47], v[140:143]
    ds_read_b128 v[84:87], v5 offset:4096
    v_mfma_f32_16x16x32_bf16 v[144:147], v[52:55], v[32:35], v[144:147]
    ds_read_b128 v[88:91], v5 offset:6144
    v_mfma_f32_16x16x32_bf16 v[148:151], v[52:55], v[36:39], v[148:151]
    ds_read_b128 v[96:99], v9 offset:0
    v_mfma_f32_16x16x32_bf16 v[152:155], v[52:55], v[40:43], v[152:155]
    ds_read_b128 v[100:103], v8 offset:4096
    v_mfma_f32_16x16x32_bf16 v[156:159], v[52:55], v[44:47], v[156:159]
    ds_read_b128 v[104:107], v9 offset:4096
    v_mfma_f32_16x16x32_bf16 v[160:163], v[56:59], v[32:35], v[160:163]
    ds_read_b128 v[108:111], v8 offset:8192
    v_mfma_f32_16x16x32_bf16 v[164:167], v[56:59], v[36:39], v[164:167]
    ds_read_b128 v[112:115], v9 offset:8192
    v_mfma_f32_16x16x32_bf16 v[168:171], v[56:59], v[40:43], v[168:171]
    ds_read_b128 v[116:119], v11 offset:0
    v_mfma_f32_16x16x32_bf16 v[172:175], v[56:59], v[44:47], v[172:175]
    v_mfma_f32_16x16x32_bf16 v[176:179], v[60:63], v[32:35], v[176:179]
    v_mfma_f32_16x16x32_bf16 v[180:183], v[60:63], v[36:39], v[180:183]
    v_mfma_f32_16x16x32_bf16 v[184:187], v[60:63], v[40:43], v[184:187]
    v_mfma_f32_16x16x32_bf16 v[188:191], v[60:63], v[44:47], v[188:191]
    v_mfma_f32_16x16x32_bf16 v[192:195], v[64:67], v[32:35], v[192:195]
    v_mfma_f32_16x16x32_bf16 v[196:199], v[64:67], v[36:39], v[196:199]
    v_mfma_f32_16x16x32_bf16 v[200:203], v[64:67], v[40:43], v[200:203]
    v_mfma_f32_16x16x32_bf16 v[204:207], v[64:67], v[44:47], v[204:207]
    v_mfma_f32_16x16x32_bf16 v[208:211], v[68:71], v[32:35], v[208:211]
    v_mfma_f32_16x16x32_bf16 v[212:215], v[68:71], v[36:39], v[212:215]
    v_mfma_f32_16x16x32_bf16 v[216:219], v[68:71], v[40:43], v[216:219]
    v_mfma_f32_16x16x32_bf16 v[220:223], v[68:71], v[44:47], v[220:223]
    v_mfma_f32_16x16x32_bf16 v[224:227], v[72:75], v[32:35], v[224:227]
    v_mfma_f32_16x16x32_bf16 v[228:231], v[72:75], v[36:39], v[228:231]
    v_mfma_f32_16x16x32_bf16 v[232:235], v[72:75], v[40:43], v[232:235]
    v_mfma_f32_16x16x32_bf16 v[236:239], v[72:75], v[44:47], v[236:239]
    s_waitcnt vmcnt(0) lgkmcnt(0)
    s_barrier
    v_mfma_f32_16x16x32_bf16 v[128:131], v[92:95], v[76:79], v[128:131]
    ds_read_b128 v[48:51], v6 offset:14336
    v_mfma_f32_16x16x32_bf16 v[132:135], v[92:95], v[80:83], v[132:135]
    ds_read_b128 v[32:35], v3 offset:32768
    v_mfma_f32_16x16x32_bf16 v[136:139], v[92:95], v[84:87], v[136:139]
    ds_read_b128 v[36:39], v3 offset:34816
    v_mfma_f32_16x16x32_bf16 v[140:143], v[92:95], v[88:91], v[140:143]
    ds_read_b128 v[40:43], v3 offset:36864
    v_mfma_f32_16x16x32_bf16 v[144:147], v[96:99], v[76:79], v[144:147]
    ds_read_b128 v[44:47], v3 offset:38912
    v_mfma_f32_16x16x32_bf16 v[148:151], v[96:99], v[80:83], v[148:151]
    ds_read_b128 v[52:55], v7 offset:14336
    v_mfma_f32_16x16x32_bf16 v[152:155], v[96:99], v[84:87], v[152:155]
    ds_read_b128 v[56:59], v6 offset:18432
    v_mfma_f32_16x16x32_bf16 v[156:159], v[96:99], v[88:91], v[156:159]
    ds_read_b128 v[60:63], v7 offset:18432
    v_mfma_f32_16x16x32_bf16 v[160:163], v[100:103], v[76:79], v[160:163]
    ds_read_b128 v[64:67], v6 offset:22528
    v_mfma_f32_16x16x32_bf16 v[164:167], v[100:103], v[80:83], v[164:167]
    ds_read_b128 v[68:71], v7 offset:22528
    v_mfma_f32_16x16x32_bf16 v[168:171], v[100:103], v[84:87], v[168:171]
    ds_read_b128 v[72:75], v10 offset:14336
    v_mfma_f32_16x16x32_bf16 v[172:175], v[100:103], v[88:91], v[172:175]
    v_mfma_f32_16x16x32_bf16 v[176:179], v[104:107], v[76:79], v[176:179]
    v_mfma_f32_16x16x32_bf16 v[180:183], v[104:107], v[80:83], v[180:183]
    v_mfma_f32_16x16x32_bf16 v[184:187], v[104:107], v[84:87], v[184:187]
    v_mfma_f32_16x16x32_bf16 v[188:191], v[104:107], v[88:91], v[188:191]
    v_mfma_f32_16x16x32_bf16 v[192:195], v[108:111], v[76:79], v[192:195]
    v_mfma_f32_16x16x32_bf16 v[196:199], v[108:111], v[80:83], v[196:199]
    v_mfma_f32_16x16x32_bf16 v[200:203], v[108:111], v[84:87], v[200:203]
    v_mfma_f32_16x16x32_bf16 v[204:207], v[108:111], v[88:91], v[204:207]
    v_mfma_f32_16x16x32_bf16 v[208:211], v[112:115], v[76:79], v[208:211]
    v_mfma_f32_16x16x32_bf16 v[212:215], v[112:115], v[80:83], v[212:215]
    v_mfma_f32_16x16x32_bf16 v[216:219], v[112:115], v[84:87], v[216:219]
    v_mfma_f32_16x16x32_bf16 v[220:223], v[112:115], v[88:91], v[220:223]
    v_mfma_f32_16x16x32_bf16 v[224:227], v[116:119], v[76:79], v[224:227]
    v_mfma_f32_16x16x32_bf16 v[228:231], v[116:119], v[80:83], v[228:231]
    v_mfma_f32_16x16x32_bf16 v[232:235], v[116:119], v[84:87], v[232:235]
    v_mfma_f32_16x16x32_bf16 v[236:239], v[116:119], v[88:91], v[236:239]
    s_waitcnt lgkmcnt(0)
    v_mfma_f32_16x16x32_bf16 v[128:131], v[48:51], v[32:35], v[128:131]
    ds_read_b128 v[92:95], v8 offset:14336
    v_mfma_f32_16x16x32_bf16 v[132:135], v[48:51], v[36:39], v[132:135]
    ds_read_b128 v[76:79], v5 offset:32768
    v_mfma_f32_16x16x32_bf16 v[136:139], v[48:51], v[40:43], v[136:139]
    ds_read_b128 v[80:83], v5 offset:34816
    v_mfma_f32_16x16x32_bf16 v[140:143], v[48:51], v[44:47], v[140:143]
    ds_read_b128 v[84:87], v5 offset:36864
    v_mfma_f32_16x16x32_bf16 v[144:147], v[52:55], v[32:35], v[144:147]
    ds_read_b128 v[88:91], v5 offset:38912
    v_mfma_f32_16x16x32_bf16 v[148:151], v[52:55], v[36:39], v[148:151]
    ds_read_b128 v[96:99], v9 offset:14336
    v_mfma_f32_16x16x32_bf16 v[152:155], v[52:55], v[40:43], v[152:155]
    ds_read_b128 v[100:103], v8 offset:18432
    v_mfma_f32_16x16x32_bf16 v[156:159], v[52:55], v[44:47], v[156:159]
    ds_read_b128 v[104:107], v9 offset:18432
    v_mfma_f32_16x16x32_bf16 v[160:163], v[56:59], v[32:35], v[160:163]
    ds_read_b128 v[108:111], v8 offset:22528
    v_mfma_f32_16x16x32_bf16 v[164:167], v[56:59], v[36:39], v[164:167]
    ds_read_b128 v[112:115], v9 offset:22528
    v_mfma_f32_16x16x32_bf16 v[168:171], v[56:59], v[40:43], v[168:171]
    ds_read_b128 v[116:119], v11 offset:14336
    v_mfma_f32_16x16x32_bf16 v[172:175], v[56:59], v[44:47], v[172:175]
    v_mfma_f32_16x16x32_bf16 v[176:179], v[60:63], v[32:35], v[176:179]
    v_mfma_f32_16x16x32_bf16 v[180:183], v[60:63], v[36:39], v[180:183]
    v_mfma_f32_16x16x32_bf16 v[184:187], v[60:63], v[40:43], v[184:187]
    v_mfma_f32_16x16x32_bf16 v[188:191], v[60:63], v[44:47], v[188:191]
    v_mfma_f32_16x16x32_bf16 v[192:195], v[64:67], v[32:35], v[192:195]
    v_mfma_f32_16x16x32_bf16 v[196:199], v[64:67], v[36:39], v[196:199]
    v_mfma_f32_16x16x32_bf16 v[200:203], v[64:67], v[40:43], v[200:203]
    v_mfma_f32_16x16x32_bf16 v[204:207], v[64:67], v[44:47], v[204:207]
    v_mfma_f32_16x16x32_bf16 v[208:211], v[68:71], v[32:35], v[208:211]
    v_mfma_f32_16x16x32_bf16 v[212:215], v[68:71], v[36:39], v[212:215]
    v_mfma_f32_16x16x32_bf16 v[216:219], v[68:71], v[40:43], v[216:219]
    v_mfma_f32_16x16x32_bf16 v[220:223], v[68:71], v[44:47], v[220:223]
    v_mfma_f32_16x16x32_bf16 v[224:227], v[72:75], v[32:35], v[224:227]
    v_mfma_f32_16x16x32_bf16 v[228:231], v[72:75], v[36:39], v[228:231]
    v_mfma_f32_16x16x32_bf16 v[232:235], v[72:75], v[40:43], v[232:235]
    v_mfma_f32_16x16x32_bf16 v[236:239], v[72:75], v[44:47], v[236:239]
    s_waitcnt lgkmcnt(0)
    v_mfma_f32_16x16x32_bf16 v[128:131], v[92:95], v[76:79], v[128:131]
    v_mfma_f32_16x16x32_bf16 v[144:147], v[96:99], v[76:79], v[144:147]
    v_mfma_f32_16x16x32_bf16 v[160:163], v[100:103], v[76:79], v[160:163]
    v_mfma_f32_16x16x32_bf16 v[176:179], v[104:107], v[76:79], v[176:179]
    v_mfma_f32_16x16x32_bf16 v[192:195], v[108:111], v[76:79], v[192:195]
    v_mfma_f32_16x16x32_bf16 v[208:211], v[112:115], v[76:79], v[208:211]
    v_mfma_f32_16x16x32_bf16 v[224:227], v[116:119], v[76:79], v[224:227]
    v_mfma_f32_16x16x32_bf16 v[132:135], v[92:95], v[80:83], v[132:135]
    v_mfma_f32_16x16x32_bf16 v[148:151], v[96:99], v[80:83], v[148:151]
    v_mfma_f32_16x16x32_bf16 v[164:167], v[100:103], v[80:83], v[164:167]
    v_cvt_pk_bf16_f32 v48, v128, v129
    v_cvt_pk_bf16_f32 v49, v130, v131
    v_cvt_pk_bf16_f32 v50, v144, v145
    v_cvt_pk_bf16_f32 v51, v146, v147
    ds_write_b128 v13, v[48:51] offset:0
    v_mfma_f32_16x16x32_bf16 v[180:183], v[104:107], v[80:83], v[180:183]
    v_cvt_pk_bf16_f32 v52, v160, v161
    v_cvt_pk_bf16_f32 v53, v162, v163
    v_cvt_pk_bf16_f32 v54, v176, v177
    v_cvt_pk_bf16_f32 v55, v178, v179
    ds_write_b128 v13, v[52:55] offset:64
    v_mfma_f32_16x16x32_bf16 v[196:199], v[108:111], v[80:83], v[196:199]
    v_cvt_pk_bf16_f32 v56, v192, v193
    v_cvt_pk_bf16_f32 v57, v194, v195
    v_cvt_pk_bf16_f32 v58, v208, v209
    v_cvt_pk_bf16_f32 v59, v210, v211
    ds_write_b128 v13, v[56:59] offset:128
    v_mfma_f32_16x16x32_bf16 v[212:215], v[112:115], v[80:83], v[212:215]
    v_cvt_pk_bf16_f32 v60, v224, v225
    v_cvt_pk_bf16_f32 v61, v226, v227
    ds_write_b64 v14, v[60:61] offset:192
    v_mfma_f32_16x16x32_bf16 v[228:231], v[116:119], v[80:83], v[228:231]
    v_mfma_f32_16x16x32_bf16 v[136:139], v[92:95], v[84:87], v[136:139]
    s_waitcnt lgkmcnt(0)
    ds_read_b128 v[16:19], v15 offset:0
    ds_read_b128 v[20:23], v15 offset:960
    ds_read_b128 v[24:27], v15 offset:1920
    ds_read_b128 v[28:31], v15 offset:2880
    v_mfma_f32_16x16x32_bf16 v[152:155], v[96:99], v[84:87], v[152:155]
    v_mfma_f32_16x16x32_bf16 v[168:171], v[100:103], v[84:87], v[168:171]
    v_cvt_pk_bf16_f32 v64, v132, v133
    v_cvt_pk_bf16_f32 v65, v134, v135
    v_cvt_pk_bf16_f32 v66, v148, v149
    v_cvt_pk_bf16_f32 v67, v150, v151
    ds_write_b128 v13, v[64:67] offset:3840
    v_mfma_f32_16x16x32_bf16 v[184:187], v[104:107], v[84:87], v[184:187]
    v_cvt_pk_bf16_f32 v68, v164, v165
    v_cvt_pk_bf16_f32 v69, v166, v167
    v_cvt_pk_bf16_f32 v70, v180, v181
    v_cvt_pk_bf16_f32 v71, v182, v183
    ds_write_b128 v13, v[68:71] offset:3904
    s_waitcnt lgkmcnt(5)
    s_mov_b32 s44, 0
    buffer_store_dwordx4 v[16:19], v12, s[24:27], s44 offen nt
    v_mfma_f32_16x16x32_bf16 v[200:203], v[108:111], v[84:87], v[200:203]
    v_cvt_pk_bf16_f32 v48, v196, v197
    v_cvt_pk_bf16_f32 v49, v198, v199
    v_cvt_pk_bf16_f32 v50, v212, v213
    v_cvt_pk_bf16_f32 v51, v214, v215
    ds_write_b128 v13, v[48:51] offset:3968
    s_waitcnt lgkmcnt(5)
    s_mov_b32 s44, 28672
    buffer_store_dwordx4 v[20:23], v12, s[24:27], s44 offen nt
    v_mfma_f32_16x16x32_bf16 v[216:219], v[112:115], v[84:87], v[216:219]
    v_cvt_pk_bf16_f32 v52, v228, v229
    v_cvt_pk_bf16_f32 v53, v230, v231
    ds_write_b64 v14, v[52:53] offset:4032
    s_waitcnt lgkmcnt(5)
    s_mov_b32 s44, 57344
    buffer_store_dwordx4 v[24:27], v12, s[24:27], s44 offen nt
    v_mfma_f32_16x16x32_bf16 v[232:235], v[116:119], v[84:87], v[232:235]
    s_waitcnt lgkmcnt(4)
    s_mov_b32 s44, 86016
    buffer_store_dwordx4 v[28:31], v12, s[24:27], s44 offen nt
    v_mfma_f32_16x16x32_bf16 v[140:143], v[92:95], v[88:91], v[140:143]
    s_waitcnt lgkmcnt(0)
    ds_read_b128 v[32:35], v15 offset:3840
    ds_read_b128 v[36:39], v15 offset:4800
    ds_read_b128 v[40:43], v15 offset:5760
    ds_read_b128 v[44:47], v15 offset:6720
    v_mfma_f32_16x16x32_bf16 v[156:159], v[96:99], v[88:91], v[156:159]
    v_mfma_f32_16x16x32_bf16 v[172:175], v[100:103], v[88:91], v[172:175]
    v_cvt_pk_bf16_f32 v56, v136, v137
    v_cvt_pk_bf16_f32 v57, v138, v139
    v_cvt_pk_bf16_f32 v58, v152, v153
    v_cvt_pk_bf16_f32 v59, v154, v155
    ds_write_b128 v13, v[56:59] offset:7680
    v_mfma_f32_16x16x32_bf16 v[188:191], v[104:107], v[88:91], v[188:191]
    v_cvt_pk_bf16_f32 v60, v168, v169
    v_cvt_pk_bf16_f32 v61, v170, v171
    v_cvt_pk_bf16_f32 v62, v184, v185
    v_cvt_pk_bf16_f32 v63, v186, v187
    ds_write_b128 v13, v[60:63] offset:7744
    s_waitcnt lgkmcnt(5)
    s_mov_b32 s44, 114688
    buffer_store_dwordx4 v[32:35], v12, s[24:27], s44 offen nt
    v_mfma_f32_16x16x32_bf16 v[204:207], v[108:111], v[88:91], v[204:207]
    v_cvt_pk_bf16_f32 v64, v200, v201
    v_cvt_pk_bf16_f32 v65, v202, v203
    v_cvt_pk_bf16_f32 v66, v216, v217
    v_cvt_pk_bf16_f32 v67, v218, v219
    ds_write_b128 v13, v[64:67] offset:7808
    s_waitcnt lgkmcnt(5)
    s_mov_b32 s44, 143360
    buffer_store_dwordx4 v[36:39], v12, s[24:27], s44 offen nt
    v_mfma_f32_16x16x32_bf16 v[220:223], v[112:115], v[88:91], v[220:223]
    v_cvt_pk_bf16_f32 v68, v232, v233
    v_cvt_pk_bf16_f32 v69, v234, v235
    ds_write_b64 v14, v[68:69] offset:7872
    s_waitcnt lgkmcnt(5)
    s_mov_b32 s44, 172032
    buffer_store_dwordx4 v[40:43], v12, s[24:27], s44 offen nt
    v_mfma_f32_16x16x32_bf16 v[236:239], v[116:119], v[88:91], v[236:239]
    s_waitcnt lgkmcnt(4)
    s_mov_b32 s44, 200704
    buffer_store_dwordx4 v[44:47], v12, s[24:27], s44 offen nt
    s_waitcnt lgkmcnt(0)
    ds_read_b128 v[16:19], v15 offset:7680
    ds_read_b128 v[20:23], v15 offset:8640
    ds_read_b128 v[24:27], v15 offset:9600
    ds_read_b128 v[28:31], v15 offset:10560
    s_nop 4
    v_cvt_pk_bf16_f32 v48, v140, v141
    v_cvt_pk_bf16_f32 v49, v142, v143
    v_cvt_pk_bf16_f32 v50, v156, v157
    v_cvt_pk_bf16_f32 v51, v158, v159
    ds_write_b128 v13, v[48:51] offset:11520
    s_waitcnt lgkmcnt(4)
    s_mov_b32 s44, 229376
    buffer_store_dwordx4 v[16:19], v12, s[24:27], s44 offen nt
    v_cvt_pk_bf16_f32 v52, v172, v173
    v_cvt_pk_bf16_f32 v53, v174, v175
    v_cvt_pk_bf16_f32 v54, v188, v189
    v_cvt_pk_bf16_f32 v55, v190, v191
    ds_write_b128 v13, v[52:55] offset:11584
    s_waitcnt lgkmcnt(4)
    s_mov_b32 s44, 258048
    buffer_store_dwordx4 v[20:23], v12, s[24:27], s44 offen nt
    v_cvt_pk_bf16_f32 v56, v204, v205
    v_cvt_pk_bf16_f32 v57, v206, v207
    v_cvt_pk_bf16_f32 v58, v220, v221
    v_cvt_pk_bf16_f32 v59, v222, v223
    ds_write_b128 v13, v[56:59] offset:11648
    s_waitcnt lgkmcnt(4)
    s_mov_b32 s44, 286720
    buffer_store_dwordx4 v[24:27], v12, s[24:27], s44 offen nt
    v_cvt_pk_bf16_f32 v60, v236, v237
    v_cvt_pk_bf16_f32 v61, v238, v239
    ds_write_b64 v14, v[60:61] offset:11712
    s_waitcnt lgkmcnt(4)
    s_mov_b32 s44, 315392
    buffer_store_dwordx4 v[28:31], v12, s[24:27], s44 offen nt
    s_waitcnt lgkmcnt(0)
    ds_read_b128 v[32:35], v15 offset:11520
    ds_read_b128 v[36:39], v15 offset:12480
    ds_read_b128 v[40:43], v15 offset:13440
    ds_read_b128 v[44:47], v15 offset:14400
    s_waitcnt lgkmcnt(3)
    s_mov_b32 s44, 344064
    buffer_store_dwordx4 v[32:35], v12, s[24:27], s44 offen nt
    s_waitcnt lgkmcnt(2)
    s_mov_b32 s44, 372736
    buffer_store_dwordx4 v[36:39], v12, s[24:27], s44 offen nt
    s_waitcnt lgkmcnt(1)
    s_mov_b32 s44, 401408
    buffer_store_dwordx4 v[40:43], v12, s[24:27], s44 offen nt
    s_waitcnt lgkmcnt(0)
    s_mov_b32 s44, 430080
    buffer_store_dwordx4 v[44:47], v12, s[24:27], s44 offen nt
    s_endpgm
L_burst:
    buffer_load_dwordx4 v[244:247], v240, s[16:19], s47 offen offset:0
    buffer_load_dwordx4 v[244:247], v240, s[16:19], s47 offen offset:896
    s_add_u32 s47, s47, 14336
    buffer_load_dwordx4 v[244:247], v240, s[16:19], s47 offen offset:0
    buffer_load_dwordx4 v[244:247], v240, s[16:19], s47 offen offset:896
    s_add_u32 s47, s47, 14336
    buffer_load_dwordx4 v[244:247], v241, s[12:15], s55 offen
    s_add_u32 s55, s55, 16384
    buffer_load_dwordx4 v[244:247], v240, s[16:19], s47 offen offset:0
    buffer_load_dwordx4 v[244:247], v240, s[16:19], s47 offen offset:896
    s_add_u32 s47, s47, 14336
    buffer_load_dwordx4 v[244:247], v240, s[16:19], s47 offen offset:0
    buffer_load_dwordx4 v[244:247], v240, s[16:19], s47 offen offset:896
    s_add_u32 s47, s47, 14336
    buffer_load_dwordx4 v[244:247], v241, s[12:15], s55 offen
    s_add_u32 s55, s55, 16384
    buffer_load_dwordx4 v[244:247], v240, s[16:19], s47 offen offset:0
    buffer_load_dwordx4 v[244:247], v240, s[16:19], s47 offen offset:896
    s_add_u32 s47, s47, 14336
    buffer_load_dwordx4 v[244:247], v240, s[16:19], s47 offen offset:0
    buffer_load_dwordx4 v[244:247], v240, s[16:19], s47 offen offset:896
    s_add_u32 s47, s47, 14336
    buffer_load_dwordx4 v[244:247], v241, s[12:15], s55 offen
    s_add_u32 s55, s55, 16384
    buffer_load_dwordx4 v[244:247], v240, s[16:19], s47 offen offset:0
    buffer_load_dwordx4 v[244:247], v240, s[16:19], s47 offen offset:896
    s_add_u32 s47, s47, 14336
    buffer_load_dwordx4 v[244:247], v240, s[16:19], s47 offen offset:0
    buffer_load_dwordx4 v[244:247], v240, s[16:19], s47 offen offset:896
    s_add_u32 s47, s47, 14336
    buffer_load_dwordx4 v[244:247], v241, s[12:15], s55 offen
    s_add_u32 s55, s55, 16384
    s_setpc_b64 s[50:51]
L_producer:
    s_setprio 3
    v_lshrrev_b32 v1, 5, v0
    v_and_b32 v2, 31, v0
    v_cmp_gt_u32 vcc, 28, v2
    v_bfrev_b32 v6, 1
    s_mul_i32 s42, s37, 229376
    s_lshl_b32 s43, s31, 2
    s_add_u32 s42, s42, s43
    v_mul_u32_u24 v3, 114688, v1
    v_lshl_add_u32 v3, v2, 4, v3
    v_add_u32 v3, s42, v3
    v_cndmask_b32 v16, v6, v3, vcc
    v_add_u32 v17, 14336, v16
    v_add_u32 v18, 28672, v16
    v_add_u32 v19, 43008, v16
    v_add_u32 v20, 57344, v16
    v_add_u32 v21, 71680, v16
    v_add_u32 v22, 86016, v16
    v_add_u32 v23, 100352, v16
    s_lshl_b32 s43, s31, 1
    v_lshlrev_b32 v3, 3, v2
    v_add_u32 v3, s43, v3
    v_mul_u32_u24 v4, 28672, v1
    v_add_u32 v3, v3, v4
    v_cndmask_b32 v34, v6, v3, vcc
    s_mov_b32 s41, 256
    s_mov_b32 s40, 0
    s_waitcnt lgkmcnt(0)
    s_mov_b32 s20, s8
    s_and_b32 s21, s9, 0xffff
    s_mov_b32 s22, 57344
    s_mov_b32 s23, 0x00020000
    s_mov_b32 s16, s6
    s_and_b32 s17, s7, 0xffff
    s_mov_b32 s18, 14680064
    s_mov_b32 s19, 0x00020000
    s_mov_b32 s42, 0
    buffer_load_dwordx2 v[92:93], v34, s[20:23], s42 offen
    s_mov_b32 s42, 7168
    buffer_load_dwordx2 v[94:95], v34, s[20:23], s42 offen
    s_mov_b32 s42, 14336
    buffer_load_dwordx2 v[96:97], v34, s[20:23], s42 offen
    s_mov_b32 s42, 21504
    buffer_load_dwordx2 v[98:99], v34, s[20:23], s42 offen
    s_mov_b32 s12, s4
    s_and_b32 s13, s5, 0xffff
    s_mov_b32 s14, 4194304
    s_mov_b32 s15, 0x00020000
    s_lshl_b32 s42, s37, 1
    v_add_u32 v3, s42, v1
    v_and_b32 v4, 7, v2
    v_lshlrev_b32 v5, 1, v2
    v_and_b32 v5, 7, v5
    v_cmp_gt_u32 s[38:39], 24, v2
    v_mov_b32 v7, 0x40000
    s_nop 0
    v_cndmask_b32 v4, v5, v4, s[38:39]
    v_xor_b32 v4, v3, v4
    v_lshlrev_b32 v4, 4, v4
    v_lshl_add_u32 v4, v2, 9, v4
    v_add_u32 v4, 131072, v4
    v_cndmask_b32 v32, v7, v4, vcc
    v_xor_b32 v4, 16, v32
    v_add_u32 v33, 256, v4
    s_waitcnt vmcnt(0)
    v_mov_b32 v100, v92
    v_mov_b32 v101, v93
    v_mov_b32 v102, v94
    v_mov_b32 v103, v95
    v_mov_b32 v104, v96
    v_mov_b32 v105, v97
    v_mov_b32 v106, v98
    v_mov_b32 v107, v99
    s_nop 1
    v_permlane32_swap_b32 v92, v100
    v_permlane32_swap_b32 v93, v101
    v_permlane32_swap_b32 v94, v102
    v_permlane32_swap_b32 v95, v103
    v_permlane32_swap_b32 v96, v104
    v_permlane32_swap_b32 v97, v105
    v_permlane32_swap_b32 v98, v106
    v_permlane32_swap_b32 v99, v107
    s_nop 1
    v_perm_b32 v60, v94, v92, s32
    v_perm_b32 v61, v98, v96, s32
    v_perm_b32 v36, v61, v60, s34
    v_perm_b32 v44, v61, v60, s35
    v_perm_b32 v60, v94, v92, s33
    v_perm_b32 v61, v98, v96, s33
    v_perm_b32 v37, v61, v60, s34
    v_perm_b32 v45, v61, v60, s35
    v_perm_b32 v60, v102, v100, s32
    v_perm_b32 v61, v106, v104, s32
    v_perm_b32 v40, v61, v60, s34
    v_perm_b32 v48, v61, v60, s35
    v_perm_b32 v60, v102, v100, s33
    v_perm_b32 v61, v106, v104, s33
    v_perm_b32 v41, v61, v60, s34
    v_perm_b32 v49, v61, v60, s35
    v_perm_b32 v60, v95, v93, s32
    v_perm_b32 v61, v99, v97, s32
    v_perm_b32 v38, v61, v60, s34
    v_perm_b32 v46, v61, v60, s35
    v_perm_b32 v60, v95, v93, s33
    v_perm_b32 v61, v99, v97, s33
    v_perm_b32 v39, v61, v60, s34
    v_perm_b32 v47, v61, v60, s35
    v_perm_b32 v60, v103, v101, s32
    v_perm_b32 v61, v107, v105, s32
    v_perm_b32 v42, v61, v60, s34
    v_perm_b32 v50, v61, v60, s35
    v_perm_b32 v60, v103, v101, s33
    v_perm_b32 v61, v107, v105, s33
    v_perm_b32 v43, v61, v60, s34
    v_perm_b32 v51, v61, v60, s35
    s_mov_b32 s38, 0x0fffffff
    s_mov_b32 s39, 0x0fffffff
    s_mov_b64 exec, s[38:39]
    buffer_load_dwordx4 v[128:131], v16, s[16:19], s40 offen
    buffer_load_dwordx4 v[132:135], v17, s[16:19], s40 offen
    buffer_load_dwordx4 v[136:139], v18, s[16:19], s40 offen
    buffer_load_dwordx4 v[140:143], v19, s[16:19], s40 offen
    buffer_load_dwordx4 v[144:147], v20, s[16:19], s40 offen
    buffer_load_dwordx4 v[148:151], v21, s[16:19], s40 offen
    buffer_load_dwordx4 v[152:155], v22, s[16:19], s40 offen
    buffer_load_dwordx4 v[156:159], v23, s[16:19], s40 offen
    s_add_u32 s40, s40, 917504
    s_setprio 0
    s_waitcnt vmcnt(0)
    buffer_load_dwordx4 v[160:163], v16, s[16:19], s40 offen
    v_lshl_or_b32 v60, v132, 8, v128
    v_lshl_or_b32 v61, v140, 8, v136
    v_lshl_or_b32 v62, v133, 8, v129
    buffer_load_dwordx4 v[164:167], v17, s[16:19], s40 offen
    v_lshl_or_b32 v63, v141, 8, v137
    v_lshl_or_b32 v64, v134, 8, v130
    v_lshl_or_b32 v65, v142, 8, v138
    v_lshl_or_b32 v66, v135, 8, v131
    buffer_load_dwordx4 v[168:171], v18, s[16:19], s40 offen
    v_lshl_or_b32 v67, v143, 8, v139
    v_lshl_or_b32 v68, v148, 8, v144
    v_lshl_or_b32 v69, v156, 8, v152
    v_lshl_or_b32 v70, v149, 8, v145
    buffer_load_dwordx4 v[172:175], v19, s[16:19], s40 offen
    v_lshl_or_b32 v71, v157, 8, v153
    v_lshl_or_b32 v72, v150, 8, v146
    v_lshl_or_b32 v73, v158, 8, v154
    v_lshl_or_b32 v74, v151, 8, v147
    buffer_load_dwordx4 v[176:179], v20, s[16:19], s40 offen
    v_lshl_or_b32 v75, v159, 8, v155
    v_lshl_or_b32 v52, v61, 16, v60
    v_lshl_or_b32 v53, v63, 16, v62
    buffer_load_dwordx4 v[180:183], v21, s[16:19], s40 offen
    v_lshl_or_b32 v54, v65, 16, v64
    v_lshl_or_b32 v55, v67, 16, v66
    v_lshl_or_b32 v56, v69, 16, v68
    v_lshl_or_b32 v57, v71, 16, v70
    buffer_load_dwordx4 v[184:187], v22, s[16:19], s40 offen
    v_lshl_or_b32 v58, v73, 16, v72
    v_lshl_or_b32 v59, v75, 16, v74
    v_perm_b32 v108, v40, v36, v52
    v_perm_b32 v109, v48, v44, v52
    buffer_load_dwordx4 v[188:191], v23, s[16:19], s40 offen
    s_add_u32 s40, s40, 917504
    v_perm_b32 v110, v40, v36, v56
    v_perm_b32 v111, v48, v44, v56
    v_perm_b32 v112, v41, v37, v53
    v_perm_b32 v113, v49, v45, v53
    buffer_load_dwordx4 v[192:195], v16, s[16:19], s40 offen
    v_perm_b32 v114, v41, v37, v57
    v_perm_b32 v115, v49, v45, v57
    v_perm_b32 v116, v42, v38, v54
    buffer_load_dwordx4 v[196:199], v17, s[16:19], s40 offen
    v_perm_b32 v117, v50, v46, v54
    v_perm_b32 v118, v42, v38, v58
    v_perm_b32 v119, v50, v46, v58
    v_perm_b32 v120, v43, v39, v55
    buffer_load_dwordx4 v[200:203], v18, s[16:19], s40 offen
    v_perm_b32 v121, v51, v47, v55
    v_perm_b32 v122, v43, v39, v59
    v_perm_b32 v123, v51, v47, v59
    v_perm_b32 v76, v109, v108, s32
    buffer_load_dwordx4 v[204:207], v19, s[16:19], s40 offen
    v_perm_b32 v77, v109, v108, s33
    v_perm_b32 v78, v111, v110, s32
    v_perm_b32 v79, v111, v110, s33
    ds_write_b128 v32, v[76:79] offset:0
    buffer_load_dwordx4 v[208:211], v20, s[16:19], s40 offen
    v_perm_b32 v80, v113, v112, s32
    v_perm_b32 v81, v113, v112, s33
    v_perm_b32 v82, v115, v114, s32
    buffer_load_dwordx4 v[212:215], v21, s[16:19], s40 offen
    v_perm_b32 v83, v115, v114, s33
    ds_write_b128 v32, v[80:83] offset:128
    v_perm_b32 v84, v117, v116, s32
    v_perm_b32 v85, v117, v116, s33
    buffer_load_dwordx4 v[216:219], v22, s[16:19], s40 offen
    v_perm_b32 v86, v119, v118, s32
    v_perm_b32 v87, v119, v118, s33
    ds_write_b128 v33, v[84:87] offset:0
    v_perm_b32 v88, v121, v120, s32
    buffer_load_dwordx4 v[220:223], v23, s[16:19], s40 offen
    s_add_u32 s40, s40, 917504
    v_perm_b32 v89, v121, v120, s33
    v_perm_b32 v90, v123, v122, s32
    v_perm_b32 v91, v123, v122, s33
    ds_write_b128 v33, v[88:91] offset:128
    s_waitcnt lgkmcnt(0)
    s_barrier
    s_waitcnt vmcnt(8)
    buffer_load_dwordx4 v[224:227], v16, s[16:19], s40 offen
    v_lshl_or_b32 v60, v164, 8, v160
    v_lshl_or_b32 v61, v172, 8, v168
    v_lshl_or_b32 v62, v165, 8, v161
    v_lshl_or_b32 v63, v173, 8, v169
    v_lshl_or_b32 v64, v166, 8, v162
    v_lshl_or_b32 v65, v174, 8, v170
    v_lshl_or_b32 v66, v167, 8, v163
    buffer_load_dwordx4 v[228:231], v17, s[16:19], s40 offen
    v_lshl_or_b32 v67, v175, 8, v171
    v_lshl_or_b32 v68, v180, 8, v176
    v_lshl_or_b32 v69, v188, 8, v184
    v_lshl_or_b32 v70, v181, 8, v177
    v_lshl_or_b32 v71, v189, 8, v185
    v_lshl_or_b32 v72, v182, 8, v178
    v_lshl_or_b32 v73, v190, 8, v186
    v_lshl_or_b32 v74, v183, 8, v179
    buffer_load_dwordx4 v[232:235], v18, s[16:19], s40 offen
    v_lshl_or_b32 v75, v191, 8, v187
    v_lshl_or_b32 v52, v61, 16, v60
    v_lshl_or_b32 v53, v63, 16, v62
    v_lshl_or_b32 v54, v65, 16, v64
    v_lshl_or_b32 v55, v67, 16, v66
    v_lshl_or_b32 v56, v69, 16, v68
    v_lshl_or_b32 v57, v71, 16, v70
    buffer_load_dwordx4 v[236:239], v19, s[16:19], s40 offen
    v_lshl_or_b32 v58, v73, 16, v72
    v_lshl_or_b32 v59, v75, 16, v74
    v_perm_b32 v108, v40, v36, v52
    v_perm_b32 v109, v48, v44, v52
    v_perm_b32 v110, v40, v36, v56
    v_perm_b32 v111, v48, v44, v56
    v_perm_b32 v112, v41, v37, v53
    v_perm_b32 v113, v49, v45, v53
    buffer_load_dwordx4 v[240:243], v20, s[16:19], s40 offen
    v_perm_b32 v114, v41, v37, v57
    v_perm_b32 v115, v49, v45, v57
    v_perm_b32 v116, v42, v38, v54
    v_perm_b32 v117, v50, v46, v54
    v_perm_b32 v118, v42, v38, v58
    v_perm_b32 v119, v50, v46, v58
    v_perm_b32 v120, v43, v39, v55
    buffer_load_dwordx4 v[244:247], v21, s[16:19], s40 offen
    v_perm_b32 v121, v51, v47, v55
    v_perm_b32 v122, v43, v39, v59
    v_perm_b32 v123, v51, v47, v59
    v_perm_b32 v76, v109, v108, s32
    v_perm_b32 v77, v109, v108, s33
    v_perm_b32 v78, v111, v110, s32
    v_perm_b32 v79, v111, v110, s33
    ds_write_b128 v32, v[76:79] offset:14336
    buffer_load_dwordx4 v[248:251], v22, s[16:19], s40 offen
    v_perm_b32 v80, v113, v112, s32
    v_perm_b32 v81, v113, v112, s33
    v_perm_b32 v82, v115, v114, s32
    v_perm_b32 v83, v115, v114, s33
    ds_write_b128 v32, v[80:83] offset:14464
    v_perm_b32 v84, v117, v116, s32
    v_perm_b32 v85, v117, v116, s33
    buffer_load_dwordx4 v[252:255], v23, s[16:19], s40 offen
    s_add_u32 s40, s40, 917504
    v_perm_b32 v86, v119, v118, s32
    v_perm_b32 v87, v119, v118, s33
    ds_write_b128 v33, v[84:87] offset:14336
    v_perm_b32 v88, v121, v120, s32
    v_perm_b32 v89, v121, v120, s33
    v_perm_b32 v90, v123, v122, s32
    v_perm_b32 v91, v123, v122, s33
    ds_write_b128 v33, v[88:91] offset:14464
    s_waitcnt lgkmcnt(0)
    s_barrier
    s_mov_b32 s48, 0
L_ploop:
    s_waitcnt vmcnt(8)
    buffer_load_dwordx4 v[128:131], v16, s[16:19], s40 offen
    v_lshl_or_b32 v60, v196, 8, v192
    v_lshl_or_b32 v61, v204, 8, v200
    v_lshl_or_b32 v62, v197, 8, v193
    v_lshl_or_b32 v63, v205, 8, v201
    v_lshl_or_b32 v64, v198, 8, v194
    v_lshl_or_b32 v65, v206, 8, v202
    v_lshl_or_b32 v66, v199, 8, v195
    buffer_load_dwordx4 v[132:135], v17, s[16:19], s40 offen
    v_lshl_or_b32 v67, v207, 8, v203
    v_lshl_or_b32 v68, v212, 8, v208
    v_lshl_or_b32 v69, v220, 8, v216
    v_lshl_or_b32 v70, v213, 8, v209
    v_lshl_or_b32 v71, v221, 8, v217
    v_lshl_or_b32 v72, v214, 8, v210
    v_lshl_or_b32 v73, v222, 8, v218
    v_lshl_or_b32 v74, v215, 8, v211
    buffer_load_dwordx4 v[136:139], v18, s[16:19], s40 offen
    v_lshl_or_b32 v75, v223, 8, v219
    v_lshl_or_b32 v52, v61, 16, v60
    v_lshl_or_b32 v53, v63, 16, v62
    v_lshl_or_b32 v54, v65, 16, v64
    v_lshl_or_b32 v55, v67, 16, v66
    v_lshl_or_b32 v56, v69, 16, v68
    v_lshl_or_b32 v57, v71, 16, v70
    buffer_load_dwordx4 v[140:143], v19, s[16:19], s40 offen
    v_lshl_or_b32 v58, v73, 16, v72
    v_lshl_or_b32 v59, v75, 16, v74
    v_perm_b32 v108, v40, v36, v52
    v_perm_b32 v109, v48, v44, v52
    v_perm_b32 v110, v40, v36, v56
    v_perm_b32 v111, v48, v44, v56
    v_perm_b32 v112, v41, v37, v53
    v_perm_b32 v113, v49, v45, v53
    buffer_load_dwordx4 v[144:147], v20, s[16:19], s40 offen
    v_perm_b32 v114, v41, v37, v57
    v_perm_b32 v115, v49, v45, v57
    v_perm_b32 v116, v42, v38, v54
    v_perm_b32 v117, v50, v46, v54
    v_perm_b32 v118, v42, v38, v58
    v_perm_b32 v119, v50, v46, v58
    v_perm_b32 v120, v43, v39, v55
    buffer_load_dwordx4 v[148:151], v21, s[16:19], s40 offen
    v_perm_b32 v121, v51, v47, v55
    v_perm_b32 v122, v43, v39, v59
    v_perm_b32 v123, v51, v47, v59
    v_perm_b32 v76, v109, v108, s32
    v_perm_b32 v77, v109, v108, s33
    v_perm_b32 v78, v111, v110, s32
    v_perm_b32 v79, v111, v110, s33
    ds_write_b128 v32, v[76:79] offset:0
    buffer_load_dwordx4 v[152:155], v22, s[16:19], s40 offen
    v_perm_b32 v80, v113, v112, s32
    v_perm_b32 v81, v113, v112, s33
    v_perm_b32 v82, v115, v114, s32
    v_perm_b32 v83, v115, v114, s33
    ds_write_b128 v32, v[80:83] offset:128
    v_perm_b32 v84, v117, v116, s32
    v_perm_b32 v85, v117, v116, s33
    buffer_load_dwordx4 v[156:159], v23, s[16:19], s40 offen
    s_add_u32 s40, s40, 917504
    v_perm_b32 v86, v119, v118, s32
    v_perm_b32 v87, v119, v118, s33
    ds_write_b128 v33, v[84:87] offset:0
    v_perm_b32 v88, v121, v120, s32
    v_perm_b32 v89, v121, v120, s33
    v_perm_b32 v90, v123, v122, s32
    v_perm_b32 v91, v123, v122, s33
    ds_write_b128 v33, v[88:91] offset:128
    s_waitcnt lgkmcnt(0)
    s_barrier
    s_waitcnt vmcnt(8)
    buffer_load_dwordx4 v[160:163], v16, s[16:19], s40 offen
    v_lshl_or_b32 v60, v228, 8, v224
    v_lshl_or_b32 v61, v236, 8, v232
    v_lshl_or_b32 v62, v229, 8, v225
    v_lshl_or_b32 v63, v237, 8, v233
    v_lshl_or_b32 v64, v230, 8, v226
    v_lshl_or_b32 v65, v238, 8, v234
    v_lshl_or_b32 v66, v231, 8, v227
    buffer_load_dwordx4 v[164:167], v17, s[16:19], s40 offen
    v_lshl_or_b32 v67, v239, 8, v235
    v_lshl_or_b32 v68, v244, 8, v240
    v_lshl_or_b32 v69, v252, 8, v248
    v_lshl_or_b32 v70, v245, 8, v241
    v_lshl_or_b32 v71, v253, 8, v249
    v_lshl_or_b32 v72, v246, 8, v242
    v_lshl_or_b32 v73, v254, 8, v250
    v_lshl_or_b32 v74, v247, 8, v243
    buffer_load_dwordx4 v[168:171], v18, s[16:19], s40 offen
    v_lshl_or_b32 v75, v255, 8, v251
    v_lshl_or_b32 v52, v61, 16, v60
    v_lshl_or_b32 v53, v63, 16, v62
    v_lshl_or_b32 v54, v65, 16, v64
    v_lshl_or_b32 v55, v67, 16, v66
    v_lshl_or_b32 v56, v69, 16, v68
    v_lshl_or_b32 v57, v71, 16, v70
    buffer_load_dwordx4 v[172:175], v19, s[16:19], s40 offen
    v_lshl_or_b32 v58, v73, 16, v72
    v_lshl_or_b32 v59, v75, 16, v74
    v_perm_b32 v108, v40, v36, v52
    v_perm_b32 v109, v48, v44, v52
    v_perm_b32 v110, v40, v36, v56
    v_perm_b32 v111, v48, v44, v56
    v_perm_b32 v112, v41, v37, v53
    v_perm_b32 v113, v49, v45, v53
    buffer_load_dwordx4 v[176:179], v20, s[16:19], s40 offen
    v_perm_b32 v114, v41, v37, v57
    v_perm_b32 v115, v49, v45, v57
    v_perm_b32 v116, v42, v38, v54
    v_perm_b32 v117, v50, v46, v54
    v_perm_b32 v118, v42, v38, v58
    v_perm_b32 v119, v50, v46, v58
    v_perm_b32 v120, v43, v39, v55
    buffer_load_dwordx4 v[180:183], v21, s[16:19], s40 offen
    v_perm_b32 v121, v51, v47, v55
    v_perm_b32 v122, v43, v39, v59
    v_perm_b32 v123, v51, v47, v59
    v_perm_b32 v76, v109, v108, s32
    v_perm_b32 v77, v109, v108, s33
    v_perm_b32 v78, v111, v110, s32
    v_perm_b32 v79, v111, v110, s33
    ds_write_b128 v32, v[76:79] offset:14336
    buffer_load_dwordx4 v[184:187], v22, s[16:19], s40 offen
    v_perm_b32 v80, v113, v112, s32
    v_perm_b32 v81, v113, v112, s33
    v_perm_b32 v82, v115, v114, s32
    v_perm_b32 v83, v115, v114, s33
    ds_write_b128 v32, v[80:83] offset:14464
    v_perm_b32 v84, v117, v116, s32
    v_perm_b32 v85, v117, v116, s33
    buffer_load_dwordx4 v[188:191], v23, s[16:19], s40 offen
    s_add_u32 s40, s40, 917504
    v_perm_b32 v86, v119, v118, s32
    v_perm_b32 v87, v119, v118, s33
    ds_write_b128 v33, v[84:87] offset:14336
    v_perm_b32 v88, v121, v120, s32
    v_perm_b32 v89, v121, v120, s33
    v_perm_b32 v90, v123, v122, s32
    v_perm_b32 v91, v123, v122, s33
    ds_write_b128 v33, v[88:91] offset:14464
    s_waitcnt lgkmcnt(0)
    s_barrier
    s_waitcnt vmcnt(8)
    buffer_load_dwordx4 v[192:195], v16, s[16:19], s40 offen
    v_lshl_or_b32 v60, v132, 8, v128
    v_lshl_or_b32 v61, v140, 8, v136
    v_lshl_or_b32 v62, v133, 8, v129
    v_lshl_or_b32 v63, v141, 8, v137
    v_lshl_or_b32 v64, v134, 8, v130
    v_lshl_or_b32 v65, v142, 8, v138
    v_lshl_or_b32 v66, v135, 8, v131
    buffer_load_dwordx4 v[196:199], v17, s[16:19], s40 offen
    v_lshl_or_b32 v67, v143, 8, v139
    v_lshl_or_b32 v68, v148, 8, v144
    v_lshl_or_b32 v69, v156, 8, v152
    v_lshl_or_b32 v70, v149, 8, v145
    v_lshl_or_b32 v71, v157, 8, v153
    v_lshl_or_b32 v72, v150, 8, v146
    v_lshl_or_b32 v73, v158, 8, v154
    v_lshl_or_b32 v74, v151, 8, v147
    buffer_load_dwordx4 v[200:203], v18, s[16:19], s40 offen
    v_lshl_or_b32 v75, v159, 8, v155
    v_lshl_or_b32 v52, v61, 16, v60
    v_lshl_or_b32 v53, v63, 16, v62
    v_lshl_or_b32 v54, v65, 16, v64
    v_lshl_or_b32 v55, v67, 16, v66
    v_lshl_or_b32 v56, v69, 16, v68
    v_lshl_or_b32 v57, v71, 16, v70
    buffer_load_dwordx4 v[204:207], v19, s[16:19], s40 offen
    v_lshl_or_b32 v58, v73, 16, v72
    v_lshl_or_b32 v59, v75, 16, v74
    v_perm_b32 v108, v40, v36, v52
    v_perm_b32 v109, v48, v44, v52
    v_perm_b32 v110, v40, v36, v56
    v_perm_b32 v111, v48, v44, v56
    v_perm_b32 v112, v41, v37, v53
    v_perm_b32 v113, v49, v45, v53
    buffer_load_dwordx4 v[208:211], v20, s[16:19], s40 offen
    v_perm_b32 v114, v41, v37, v57
    v_perm_b32 v115, v49, v45, v57
    v_perm_b32 v116, v42, v38, v54
    v_perm_b32 v117, v50, v46, v54
    v_perm_b32 v118, v42, v38, v58
    v_perm_b32 v119, v50, v46, v58
    v_perm_b32 v120, v43, v39, v55
    buffer_load_dwordx4 v[212:215], v21, s[16:19], s40 offen
    v_perm_b32 v121, v51, v47, v55
    v_perm_b32 v122, v43, v39, v59
    v_perm_b32 v123, v51, v47, v59
    v_perm_b32 v76, v109, v108, s32
    v_perm_b32 v77, v109, v108, s33
    v_perm_b32 v78, v111, v110, s32
    v_perm_b32 v79, v111, v110, s33
    ds_write_b128 v32, v[76:79] offset:0
    buffer_load_dwordx4 v[216:219], v22, s[16:19], s40 offen
    v_perm_b32 v80, v113, v112, s32
    v_perm_b32 v81, v113, v112, s33
    v_perm_b32 v82, v115, v114, s32
    v_perm_b32 v83, v115, v114, s33
    ds_write_b128 v32, v[80:83] offset:128
    v_perm_b32 v84, v117, v116, s32
    v_perm_b32 v85, v117, v116, s33
    buffer_load_dwordx4 v[220:223], v23, s[16:19], s40 offen
    s_add_u32 s40, s40, 917504
    v_perm_b32 v86, v119, v118, s32
    v_perm_b32 v87, v119, v118, s33
    ds_write_b128 v33, v[84:87] offset:0
    v_perm_b32 v88, v121, v120, s32
    v_perm_b32 v89, v121, v120, s33
    v_perm_b32 v90, v123, v122, s32
    v_perm_b32 v91, v123, v122, s33
    ds_write_b128 v33, v[88:91] offset:128
    s_waitcnt lgkmcnt(0)
    s_barrier
    s_waitcnt vmcnt(8)
    buffer_load_dwordx4 v[224:227], v16, s[16:19], s40 offen
    v_lshl_or_b32 v60, v164, 8, v160
    v_lshl_or_b32 v61, v172, 8, v168
    v_lshl_or_b32 v62, v165, 8, v161
    v_lshl_or_b32 v63, v173, 8, v169
    v_lshl_or_b32 v64, v166, 8, v162
    v_lshl_or_b32 v65, v174, 8, v170
    v_lshl_or_b32 v66, v167, 8, v163
    buffer_load_dwordx4 v[228:231], v17, s[16:19], s40 offen
    v_lshl_or_b32 v67, v175, 8, v171
    v_lshl_or_b32 v68, v180, 8, v176
    v_lshl_or_b32 v69, v188, 8, v184
    v_lshl_or_b32 v70, v181, 8, v177
    v_lshl_or_b32 v71, v189, 8, v185
    v_lshl_or_b32 v72, v182, 8, v178
    v_lshl_or_b32 v73, v190, 8, v186
    v_lshl_or_b32 v74, v183, 8, v179
    buffer_load_dwordx4 v[232:235], v18, s[16:19], s40 offen
    v_lshl_or_b32 v75, v191, 8, v187
    v_lshl_or_b32 v52, v61, 16, v60
    v_lshl_or_b32 v53, v63, 16, v62
    v_lshl_or_b32 v54, v65, 16, v64
    v_lshl_or_b32 v55, v67, 16, v66
    v_lshl_or_b32 v56, v69, 16, v68
    v_lshl_or_b32 v57, v71, 16, v70
    buffer_load_dwordx4 v[236:239], v19, s[16:19], s40 offen
    v_lshl_or_b32 v58, v73, 16, v72
    v_lshl_or_b32 v59, v75, 16, v74
    v_perm_b32 v108, v40, v36, v52
    v_perm_b32 v109, v48, v44, v52
    v_perm_b32 v110, v40, v36, v56
    v_perm_b32 v111, v48, v44, v56
    v_perm_b32 v112, v41, v37, v53
    v_perm_b32 v113, v49, v45, v53
    buffer_load_dwordx4 v[240:243], v20, s[16:19], s40 offen
    v_perm_b32 v114, v41, v37, v57
    v_perm_b32 v115, v49, v45, v57
    v_perm_b32 v116, v42, v38, v54
    v_perm_b32 v117, v50, v46, v54
    v_perm_b32 v118, v42, v38, v58
    v_perm_b32 v119, v50, v46, v58
    v_perm_b32 v120, v43, v39, v55
    buffer_load_dwordx4 v[244:247], v21, s[16:19], s40 offen
    v_perm_b32 v121, v51, v47, v55
    v_perm_b32 v122, v43, v39, v59
    v_perm_b32 v123, v51, v47, v59
    v_perm_b32 v76, v109, v108, s32
    v_perm_b32 v77, v109, v108, s33
    v_perm_b32 v78, v111, v110, s32
    v_perm_b32 v79, v111, v110, s33
    ds_write_b128 v32, v[76:79] offset:14336
    buffer_load_dwordx4 v[248:251], v22, s[16:19], s40 offen
    v_perm_b32 v80, v113, v112, s32
    v_perm_b32 v81, v113, v112, s33
    v_perm_b32 v82, v115, v114, s32
    v_perm_b32 v83, v115, v114, s33
    ds_write_b128 v32, v[80:83] offset:14464
    v_perm_b32 v84, v117, v116, s32
    v_perm_b32 v85, v117, v116, s33
    buffer_load_dwordx4 v[252:255], v23, s[16:19], s40 offen
    s_add_u32 s40, s40, 917504
    v_perm_b32 v86, v119, v118, s32
    v_perm_b32 v87, v119, v118, s33
    ds_write_b128 v33, v[84:87] offset:14336
    v_perm_b32 v88, v121, v120, s32
    v_perm_b32 v89, v121, v120, s33
    v_perm_b32 v90, v123, v122, s32
    v_perm_b32 v91, v123, v122, s33
    ds_write_b128 v33, v[88:91] offset:14464
    s_waitcnt lgkmcnt(0)
    s_barrier
    s_add_u32 s48, s48, 1
    s_cmp_lt_u32 s48, 3
    s_cbranch_scc1 L_ploop
    s_waitcnt vmcnt(8)
    v_lshl_or_b32 v60, v196, 8, v192
    v_lshl_or_b32 v61, v204, 8, v200
    v_lshl_or_b32 v62, v197, 8, v193
    v_lshl_or_b32 v63, v205, 8, v201
    v_lshl_or_b32 v64, v198, 8, v194
    v_lshl_or_b32 v65, v206, 8, v202
    v_lshl_or_b32 v66, v199, 8, v195
    v_lshl_or_b32 v67, v207, 8, v203
    v_lshl_or_b32 v68, v212, 8, v208
    v_lshl_or_b32 v69, v220, 8, v216
    v_lshl_or_b32 v70, v213, 8, v209
    v_lshl_or_b32 v71, v221, 8, v217
    v_lshl_or_b32 v72, v214, 8, v210
    v_lshl_or_b32 v73, v222, 8, v218
    v_lshl_or_b32 v74, v215, 8, v211
    v_lshl_or_b32 v75, v223, 8, v219
    v_lshl_or_b32 v52, v61, 16, v60
    v_lshl_or_b32 v53, v63, 16, v62
    v_lshl_or_b32 v54, v65, 16, v64
    v_lshl_or_b32 v55, v67, 16, v66
    v_lshl_or_b32 v56, v69, 16, v68
    v_lshl_or_b32 v57, v71, 16, v70
    v_lshl_or_b32 v58, v73, 16, v72
    v_lshl_or_b32 v59, v75, 16, v74
    v_perm_b32 v108, v40, v36, v52
    v_perm_b32 v109, v48, v44, v52
    v_perm_b32 v110, v40, v36, v56
    v_perm_b32 v111, v48, v44, v56
    v_perm_b32 v112, v41, v37, v53
    v_perm_b32 v113, v49, v45, v53
    v_perm_b32 v114, v41, v37, v57
    v_perm_b32 v115, v49, v45, v57
    v_perm_b32 v116, v42, v38, v54
    v_perm_b32 v117, v50, v46, v54
    v_perm_b32 v118, v42, v38, v58
    v_perm_b32 v119, v50, v46, v58
    v_perm_b32 v120, v43, v39, v55
    v_perm_b32 v121, v51, v47, v55
    v_perm_b32 v122, v43, v39, v59
    v_perm_b32 v123, v51, v47, v59
    v_perm_b32 v76, v109, v108, s32
    v_perm_b32 v77, v109, v108, s33
    v_perm_b32 v78, v111, v110, s32
    v_perm_b32 v79, v111, v110, s33
    ds_write_b128 v32, v[76:79] offset:0
    v_perm_b32 v80, v113, v112, s32
    v_perm_b32 v81, v113, v112, s33
    v_perm_b32 v82, v115, v114, s32
    v_perm_b32 v83, v115, v114, s33
    ds_write_b128 v32, v[80:83] offset:128
    v_perm_b32 v84, v117, v116, s32
    v_perm_b32 v85, v117, v116, s33
    v_perm_b32 v86, v119, v118, s32
    v_perm_b32 v87, v119, v118, s33
    ds_write_b128 v33, v[84:87] offset:0
    v_perm_b32 v88, v121, v120, s32
    v_perm_b32 v89, v121, v120, s33
    v_perm_b32 v90, v123, v122, s32
    v_perm_b32 v91, v123, v122, s33
    ds_write_b128 v33, v[88:91] offset:128
    s_waitcnt lgkmcnt(0)
    s_barrier
    s_waitcnt vmcnt(0)
    v_lshl_or_b32 v60, v228, 8, v224
    v_lshl_or_b32 v61, v236, 8, v232
    v_lshl_or_b32 v62, v229, 8, v225
    v_lshl_or_b32 v63, v237, 8, v233
    v_lshl_or_b32 v64, v230, 8, v226
    v_lshl_or_b32 v65, v238, 8, v234
    v_lshl_or_b32 v66, v231, 8, v227
    v_lshl_or_b32 v67, v239, 8, v235
    v_lshl_or_b32 v68, v244, 8, v240
    v_lshl_or_b32 v69, v252, 8, v248
    v_lshl_or_b32 v70, v245, 8, v241
    v_lshl_or_b32 v71, v253, 8, v249
    v_lshl_or_b32 v72, v246, 8, v242
    v_lshl_or_b32 v73, v254, 8, v250
    v_lshl_or_b32 v74, v247, 8, v243
    v_lshl_or_b32 v75, v255, 8, v251
    v_lshl_or_b32 v52, v61, 16, v60
    v_lshl_or_b32 v53, v63, 16, v62
    v_lshl_or_b32 v54, v65, 16, v64
    v_lshl_or_b32 v55, v67, 16, v66
    v_lshl_or_b32 v56, v69, 16, v68
    v_lshl_or_b32 v57, v71, 16, v70
    v_lshl_or_b32 v58, v73, 16, v72
    v_lshl_or_b32 v59, v75, 16, v74
    v_perm_b32 v108, v40, v36, v52
    v_perm_b32 v109, v48, v44, v52
    v_perm_b32 v110, v40, v36, v56
    v_perm_b32 v111, v48, v44, v56
    v_perm_b32 v112, v41, v37, v53
    v_perm_b32 v113, v49, v45, v53
    v_perm_b32 v114, v41, v37, v57
    v_perm_b32 v115, v49, v45, v57
    v_perm_b32 v116, v42, v38, v54
    v_perm_b32 v117, v50, v46, v54
    v_perm_b32 v118, v42, v38, v58
    v_perm_b32 v119, v50, v46, v58
    v_perm_b32 v120, v43, v39, v55
    v_perm_b32 v121, v51, v47, v55
    v_perm_b32 v122, v43, v39, v59
    v_perm_b32 v123, v51, v47, v59
    v_perm_b32 v76, v109, v108, s32
    v_perm_b32 v77, v109, v108, s33
    v_perm_b32 v78, v111, v110, s32
    v_perm_b32 v79, v111, v110, s33
    ds_write_b128 v32, v[76:79] offset:14336
    v_perm_b32 v80, v113, v112, s32
    v_perm_b32 v81, v113, v112, s33
    v_perm_b32 v82, v115, v114, s32
    v_perm_b32 v83, v115, v114, s33
    ds_write_b128 v32, v[80:83] offset:14464
    v_perm_b32 v84, v117, v116, s32
    v_perm_b32 v85, v117, v116, s33
    v_perm_b32 v86, v119, v118, s32
    v_perm_b32 v87, v119, v118, s33
    ds_write_b128 v33, v[84:87] offset:14336
    v_perm_b32 v88, v121, v120, s32
    v_perm_b32 v89, v121, v120, s33
    v_perm_b32 v90, v123, v122, s32
    v_perm_b32 v91, v123, v122, s33
    ds_write_b128 v33, v[88:91] offset:14464
    s_waitcnt lgkmcnt(0)
    s_barrier
L_end:
    s_endpgm
L_codeend:
.section .rodata,"a"
.p2align 6
.amdhsa_kernel standalone__weight_only_int_squeezellm__prompt_kernel
  .amdhsa_next_free_vgpr 256
  .amdhsa_next_free_sgpr 80
  .amdhsa_accum_offset 256
  .amdhsa_group_segment_fixed_size 0
  .amdhsa_kernarg_size 48
  .amdhsa_user_sgpr_count 2
  .amdhsa_user_sgpr_kernarg_segment_ptr 1
  .amdhsa_system_sgpr_workgroup_id_x 1
.end_amdhsa_kernel
```
